```python
import torch

def _softmax(x, axis=-1):
    return torch.softmax(x, dim=axis)
def _gelu(x):
    return torch.nn.functional.gelu(x, approximate="tanh")
def _silu(x):
    return torch.nn.functional.silu(x)
def _sigmoid(x):
    return torch.sigmoid(x)
def _layernorm(x, axis=-1, eps=1e-5):
    m = x.mean(dim=axis, keepdim=True)
    v = x.var(dim=axis, keepdim=True, unbiased=False)
    return (x - m) / torch.sqrt(v + eps)
def _scatter_add(tgt, idx, src, axis=0):
    return tgt.clone().index_add_(axis, idx, src)
def _segment_sum(src, seg, n):
    out = torch.zeros((n,) + src.shape[1:], dtype=src.dtype)
    return out.index_add_(0, seg, src)
def _pad(x, pw):
    flat = tuple(v for pair in reversed(pw) for v in pair)
    return torch.nn.functional.pad(x, flat)

kernel_name = 'gated_mix__mha_block__softmax_full_mha__prompt'

def setup_inputs():

    _w = (lambda a: (lambda t: t.to(torch.bfloat16) if t.is_floating_point() else t)(torch.as_tensor(a)))
    def _A_setup():
        B, S, D, H = 1, 2048, 1024, 32
        return {
            "x": _w((lambda *s: torch.randn(*s, dtype=torch.bfloat16) * 0.05)(B, S, D)),
            "wqkv": _w((lambda *s: torch.randn(*s, dtype=torch.bfloat16) * 0.8)(D, 3 * D)),
            "wo": _w((lambda *s: torch.randn(*s, dtype=torch.bfloat16) * 0.05)(D, D)),
        }
    _A_in = _A_setup()

    def _B_setup():
        B, S, D = 1, 2048, 1024
        return {
            "x": _w((lambda *s: torch.randn(*s, dtype=torch.bfloat16) * 0.05)(B, S, D)),
            "wqkv": _w((lambda *s: torch.randn(*s, dtype=torch.bfloat16) * 0.8)(D, 3 * D)),
            "wo": _w((lambda *s: torch.randn(*s, dtype=torch.bfloat16) * 0.05)(D, D)),
        }
    _B_in = _B_setup()

    return {
        "A_x": _A_in["x"],
        "A_wqkv": _A_in["wqkv"],
        "A_wo": _A_in["wo"],
        "B_x": _B_in["x"],
        "B_wqkv": _B_in["wqkv"],
        "B_wo": _B_in["wo"],
        "gate_w": _w((lambda *s: torch.randn(*s, dtype=torch.bfloat16) * 0.05)(1024) * 16.0),
    }

def reference(A_x, A_wqkv, A_wo, B_x, B_wqkv, B_wo, gate_w):
    def _A_ref(x, wqkv, wo):
        B, S, D = x.shape
        H = 32
        Dh = D // H
        qkv = (lambda x, *d: x.permute(*d))((x @ wqkv).reshape(B, S, 3, H, Dh), 2, 0, 3, 1, 4)
        q, k, v = qkv[0], qkv[1], qkv[2]
        scores = torch.einsum("bhqd,bhkd->bhqk", q, k) * (Dh ** -0.5)
        p = _softmax(scores, axis=-1)
        o = torch.einsum("bhqk,bhkd->bhqd", p, v)
        return (lambda x, *d: x.permute(*d))(o, 0, 2, 1, 3).reshape(B, S, D) @ wo

    def _B_ref(x, wqkv, wo):
        B, S, D = x.shape
        H = 32; Dh = D // H
        qkv = (lambda x, *d: x.permute(*d))((x @ wqkv).reshape(B, S, 3, H, Dh), 2, 0, 3, 1, 4)
        q, k, v = qkv[0], qkv[1], qkv[2]
        scale = Dh ** -0.5
        scores = torch.einsum("bhqd,bhkd->bhqk", q, k) * scale
        p = _softmax(scores, axis=-1)
        o = torch.einsum("bhqk,bhkd->bhqd", p, v)
        return (lambda x, *d: x.permute(*d))(o, 0, 2, 1, 3).reshape(B, S, D) @ wo

    x = A_x
    g = _sigmoid((x * gate_w).sum(-1, keepdims=True))
    a = _A_ref(x, A_wqkv, A_wo)
    b = _B_ref(x, B_wqkv, B_wo)
    return g * a + (1 - g) * b
```

```asm
; @launch grid=(256,1,1) block=(512,1,1) lds=163840
.amdgcn_target "amdgcn-amd-amdhsa--gfx950"
.text
.globl gated_mix__mha_block__softmax_full_mha__prompt_kernel
.p2align 8
.type gated_mix__mha_block__softmax_full_mha__prompt_kernel,@function
gated_mix__mha_block__softmax_full_mha__prompt_kernel:
    s_cmp_ge_u32 s2, 256
    s_cbranch_scc1 L_end12
    s_getpc_b64 s[92:93]
L_pc12:
    s_mov_b32 s3, L_end12-L_pc12
    v_lshlrev_b32 v1, 6, v0
    v_min_u32 v1, s3, v1
    global_load_dword v33, v1, s[92:93]
    s_load_dwordx4 s[56:59], s[0:1], 0
    s_load_dwordx2 s[60:61], s[0:1], 32
    s_load_dwordx2 s[62:63], s[0:1], 48
    s_load_dwordx4 s[88:91], s[0:1], 64
    s_load_dwordx2 s[94:95], s[0:1], 16
    s_load_dwordx2 s[96:97], s[0:1], 40
    s_load_dwordx2 s[98:99], s[0:1], 56
    v_lshrrev_b32 v1, 6, v0
    v_and_b32 v0, 63, v0
    s_and_b32 s3, s2, 7
    v_readfirstlane_b32 s28, v1
    s_lshr_b32 s4, s2, 3
    s_add_u32 s5, s4, 0
    s_and_b32 s5, s5, 3
    s_lshl_b32 s3, s3, 2
    s_add_u32 s31, s3, s5
    s_lshr_b32 s32, s4, 2
    s_lshr_b32 s29, s28, 2
    s_and_b32 s30, s28, 3
    s_lshl_b32 s33, s28, 10
    v_lshrrev_b32 v13, 3, v0
    v_and_b32 v14, 7, v0
    s_and_b32 s40, s28, 1
    s_lshl_b32 s40, s40, 2
    v_lshrrev_b32 v15, 1, v13
    v_add_u32 v1, s40, v15
    v_xor_b32 v1, v1, v14
    s_lshl_b32 s41, s28, 3
    v_add_u32 v13, s41, v13
    v_lshlrev_b32 v2, 11, v13
    v_lshl_add_u32 v2, v1, 4, v2
    v_and_b32 v15, 1, v15
    v_lshlrev_b32 v15, 2, v15
    v_xor_b32 v15, v15, v14
    s_and_b32 s41, s28, 1
    s_lshl_b32 s41, s41, 1
    v_xor_b32 v15, s41, v15
    s_mov_b32 s41, 6144
    v_mul_lo_u32 v3, v13, s41
    v_lshl_add_u32 v3, v15, 4, v3
    s_lshl_b32 s34, s32, 19
    s_and_b32 s35, s31, 15
    s_lshl_b32 s35, s35, 7
    v_and_b32 v13, 15, v0
    v_lshrrev_b32 v14, 4, v0
    v_bfe_u32 v15, v13, 1, 3
    v_xor_b32 v15, v15, v14
    v_lshlrev_b32 v4, 7, v13
    v_lshl_add_u32 v4, v15, 4, v4
    v_bfe_u32 v13, v0, 2, 2
    v_lshl_add_u32 v1, v14, 3, v13
    v_lshlrev_b32 v5, 7, v1
    v_bfe_u32 v15, v0, 1, 1
    s_lshl_b32 s41, s29, 2
    v_add_u32 v15, s41, v15
    v_lshrrev_b32 v13, 1, v13
    v_lshlrev_b32 v13, 2, v13
    v_xor_b32 v15, v15, v13
    v_and_b32 v14, 1, v14
    v_lshlrev_b32 v14, 1, v14
    v_xor_b32 v15, v15, v14
    v_lshl_add_u32 v5, v15, 4, v5
    v_and_b32 v1, 1, v0
    v_lshl_add_u32 v5, v1, 3, v5
    v_lshlrev_b32 v10, 4, v0
    s_add_u32 s44, s30, 3
    s_lshl_b32 s44, s44, 13
    s_waitcnt lgkmcnt(0)
    s_mov_b32 s8, s56
    s_mov_b32 s9, s57
    s_mov_b32 s10, 4194304
    s_mov_b32 s11, 0x00020000
    s_cmp_ge_u32 s31, 16
    s_cselect_b32 s12, s60, s58
    s_cselect_b32 s13, s61, s59
    s_mov_b32 s14, 6291456
    s_mov_b32 s15, 0x00020000
    s_add_u32 m0, s33, 0
    s_add_u32 s40, s35, 0
    buffer_load_dwordx4 v3, s[12:15], s40 offen lds
    s_add_u32 m0, s33, 8192
    s_add_u32 s40, s35, 2048
    buffer_load_dwordx4 v3, s[12:15], s40 offen lds
    s_add_u32 m0, s33, 16384
    s_add_u32 s40, s35, 4096
    buffer_load_dwordx4 v3, s[12:15], s40 offen lds
    s_add_u32 m0, s33, 24576
    s_add_u32 s40, s34, 0
    buffer_load_dwordx4 v2, s[8:11], s40 offen lds
    s_add_u32 m0, s33, 32768
    s_add_u32 s40, s34, 131072
    buffer_load_dwordx4 v2, s[8:11], s40 offen lds
    s_add_u32 m0, s33, 40960
    s_add_u32 s40, s34, 262144
    buffer_load_dwordx4 v2, s[8:11], s40 offen lds
    s_add_u32 m0, s33, 49152
    s_add_u32 s40, s34, 393216
    buffer_load_dwordx4 v2, s[8:11], s40 offen lds
    s_add_u32 m0, s33, 57344
    s_add_u32 s40, s35, 393216
    buffer_load_dwordx4 v3, s[12:15], s40 offen lds
    s_add_u32 m0, s33, 65536
    s_add_u32 s40, s35, 395264
    buffer_load_dwordx4 v3, s[12:15], s40 offen lds
    s_add_u32 m0, s33, 73728
    s_add_u32 s40, s35, 397312
    buffer_load_dwordx4 v3, s[12:15], s40 offen lds
    s_add_u32 m0, s33, 81920
    s_add_u32 s40, s34, 128
    buffer_load_dwordx4 v2, s[8:11], s40 offen lds
    s_add_u32 m0, s33, 90112
    s_add_u32 s40, s34, 131200
    buffer_load_dwordx4 v2, s[8:11], s40 offen lds
    s_add_u32 m0, s33, 98304
    s_add_u32 s40, s34, 262272
    buffer_load_dwordx4 v2, s[8:11], s40 offen lds
    s_add_u32 m0, s33, 106496
    s_add_u32 s40, s34, 393344
    buffer_load_dwordx4 v2, s[8:11], s40 offen lds
    s_add_u32 s34, s34, 256
    s_add_u32 s35, s35, 786432
    s_mov_b32 s36, 0
    v_add_u32 v7, s36, v5
    v_xor_b32 v48, 32, v7
    s_add_u32 s40, s36, 8192
    s_sub_u32 s41, s40, 163840
    s_cselect_b32 s41, s40, s41
    v_add_u32 v8, s41, v5
    v_xor_b32 v49, 32, v8
    s_add_u32 s40, s36, 16384
    s_sub_u32 s41, s40, 163840
    s_cselect_b32 s41, s40, s41
    v_add_u32 v9, s41, v5
    v_xor_b32 v50, 32, v9
    s_add_u32 s40, s36, s44
    s_sub_u32 s41, s40, 163840
    s_cselect_b32 s41, s40, s41
    v_add_u32 v11, s41, v4
    v_mov_b32 v6, v11
    s_waitcnt vmcnt(7)
    s_barrier
    ds_read_b64_tr_b16 v[80:81], v7 offset:0
    ds_read_b64_tr_b16 v[82:83], v7 offset:512
    ds_read_b128 v[64:67], v6 offset:0
    ds_read_b128 v[68:71], v6 offset:2048
    ds_read_b128 v[72:75], v6 offset:4096
    ds_read_b128 v[76:79], v6 offset:6144
    ds_read_b64_tr_b16 v[84:85], v48 offset:0
    ds_read_b64_tr_b16 v[86:87], v48 offset:512
    ds_read_b64_tr_b16 v[88:89], v8 offset:0
    ds_read_b64_tr_b16 v[90:91], v8 offset:512
    ds_read_b64_tr_b16 v[92:93], v49 offset:0
    ds_read_b64_tr_b16 v[94:95], v49 offset:512
    ds_read_b64_tr_b16 v[96:97], v9 offset:0
    ds_read_b64_tr_b16 v[98:99], v9 offset:512
    ds_read_b64_tr_b16 v[100:101], v50 offset:0
    ds_read_b64_tr_b16 v[102:103], v50 offset:512
    v_xor_b32 v6, 64, v11
    s_waitcnt lgkmcnt(0)
    v_mfma_f32_16x16x32_bf16 v[160:163], v[80:83], v[64:67], 0
    ds_read_b64_tr_b16 v[120:121], v7 offset:4096
    s_setprio 1
    s_add_u32 m0, s33, 114688
    s_add_u32 s40, s35, 0
    buffer_load_dwordx4 v3, s[12:15], s40 offen lds
    s_add_u32 m0, s33, 122880
    s_add_u32 s40, s35, 2048
    buffer_load_dwordx4 v3, s[12:15], s40 offen lds
    v_mfma_f32_16x16x32_bf16 v[164:167], v[80:83], v[68:71], 0
    ds_read_b64_tr_b16 v[122:123], v7 offset:4608
    s_add_u32 m0, s33, 131072
    s_add_u32 s40, s35, 4096
    buffer_load_dwordx4 v3, s[12:15], s40 offen lds
    v_mfma_f32_16x16x32_bf16 v[168:171], v[80:83], v[72:75], 0
    ds_read_b128 v[104:107], v6 offset:0
    s_add_u32 m0, s33, 139264
    s_add_u32 s40, s34, 0
    buffer_load_dwordx4 v2, s[8:11], s40 offen lds
    v_mfma_f32_16x16x32_bf16 v[172:175], v[80:83], v[76:79], 0
    ds_read_b128 v[108:111], v6 offset:2048
    s_add_u32 m0, s33, 147456
    s_add_u32 s40, s34, 131072
    buffer_load_dwordx4 v2, s[8:11], s40 offen lds
    v_mfma_f32_16x16x32_bf16 v[176:179], v[84:87], v[64:67], 0
    ds_read_b128 v[112:115], v6 offset:4096
    s_add_u32 m0, s33, 155648
    s_add_u32 s40, s34, 262144
    buffer_load_dwordx4 v2, s[8:11], s40 offen lds
    v_mfma_f32_16x16x32_bf16 v[180:183], v[84:87], v[68:71], 0
    ds_read_b128 v[116:119], v6 offset:6144
    s_mov_b32 s16, s90
    s_mov_b32 s17, s91
    s_mov_b32 s18, 268435456
    s_mov_b32 s19, 0x00020000
    v_mfma_f32_16x16x32_bf16 v[184:187], v[84:87], v[72:75], 0
    ds_read_b64_tr_b16 v[124:125], v48 offset:4096
    s_mov_b32 s20, s88
    s_mov_b32 s21, s89
    s_mov_b32 s22, 256
    s_mov_b32 s23, 0x00020000
    v_mfma_f32_16x16x32_bf16 v[188:191], v[84:87], v[76:79], 0
    ds_read_b64_tr_b16 v[126:127], v48 offset:4608
    s_mov_b32 s24, s62
    s_mov_b32 s25, s63
    s_mov_b32 s26, 2048
    s_mov_b32 s27, 0x00020000
    v_mfma_f32_16x16x32_bf16 v[192:195], v[88:91], v[64:67], 0
    ds_read_b64_tr_b16 v[128:129], v8 offset:4096
    s_and_b32 s3, s2, 7
    s_lshr_b32 s41, s2, 3
    s_lshr_b32 s40, s3, 1
    s_lshl_b32 s40, s40, 2
    s_and_b32 s60, s41, 3
    s_add_u32 s60, s40, s60
    s_and_b32 s40, s3, 1
    s_lshl_b32 s40, s40, 3
    s_lshr_b32 s41, s41, 2
    s_add_u32 s61, s40, s41
    s_lshl_b32 s62, s61, 0
    s_add_u32 s62, s60, s62
    s_and_b32 s62, s62, 15
    s_lshl_b32 s63, s60, 4
    s_add_u32 s63, s63, s61
    s_lshl_b32 s63, s63, 7
    s_add_u32 s63, s63, 26279936
    v_mfma_f32_16x16x32_bf16 v[196:199], v[88:91], v[68:71], 0
    ds_read_b64_tr_b16 v[130:131], v8 offset:4608
    s_cmp_eq_u32 s29, 1
    s_cselect_b32 s4, s96, s94
    s_cselect_b32 s5, s97, s95
    s_mov_b32 s6, 2097152
    s_mov_b32 s7, 0x00020000
    v_mfma_f32_16x16x32_bf16 v[200:203], v[88:91], v[72:75], 0
    ds_read_b64_tr_b16 v[132:133], v49 offset:4096
    s_mov_b32 s56, s98
    s_mov_b32 s57, s99
    s_mov_b32 s58, 4194304
    s_mov_b32 s59, 0x00020000
    v_mfma_f32_16x16x32_bf16 v[204:207], v[88:91], v[76:79], 0
    ds_read_b64_tr_b16 v[134:135], v49 offset:4608
    s_lshl_b32 s54, s31, 3
    s_add_u32 s54, s54, s32
    s_lshl_b32 s54, s54, 7
    s_add_u32 s54, s54, 26214400
    s_lshl_b32 s53, s31, 3
    v_mfma_f32_16x16x32_bf16 v[208:211], v[92:95], v[64:67], 0
    ds_read_b64_tr_b16 v[136:137], v9 offset:4096
    s_setprio 0
    s_cmp_eq_u32 s28, 0
    s_cselect_b32 s66, 5, 0xffff
    s_cselect_b32 s67, 11, 0xffff
    s_cbranch_scc0 L_nr_1
    v_lshlrev_b32 v12, 2, v0
    s_sub_u32 s40, s63, 128
    v_mov_b32 v13, s54
    v_mov_b32 v14, s40
    v_cmp_gt_u32 vcc, 32, v0
    s_nop 1
    v_cndmask_b32 v13, v14, v13, vcc
    v_add_u32 v12, v12, v13
    v_mov_b32 v13, 0
    buffer_store_dword v13, v12, s[16:19], 0 offen sc1
L_nr_1:
    v_mfma_f32_16x16x32_bf16 v[212:215], v[92:95], v[68:71], 0
    ds_read_b64_tr_b16 v[138:139], v9 offset:4608
    s_and_b32 s40, s31, 15
    s_lshl_b32 s40, s40, 3
    s_add_u32 s40, s40, s32
    s_lshl_b32 s40, s40, 3
    s_add_u32 s40, s40, s28
    s_lshl_b32 s40, s40, 10
    s_add_u32 s47, s40, 1179648
    v_mfma_f32_16x16x32_bf16 v[216:219], v[92:95], v[72:75], 0
    ds_read_b64_tr_b16 v[140:141], v50 offset:4096
    s_lshl_b32 s40, s32, 8
    s_lshl_b32 s41, s31, 3
    s_add_u32 s40, s40, s41
    s_add_u32 s40, s40, s28
    s_lshl_b32 s68, s40, 2
    s_lshl_b32 s41, s40, 11
    v_lshlrev_b32 v12, 5, v0
    buffer_load_dwordx4 v[16:19], v12, s[8:11], s41 offen
    buffer_load_dwordx4 v[20:23], v12, s[8:11], s41 offen offset:16
    v_mfma_f32_16x16x32_bf16 v[220:223], v[92:95], v[76:79], 0
    ds_read_b64_tr_b16 v[142:143], v50 offset:4608
    v_lshlrev_b32 v12, 5, v0
    buffer_load_dwordx4 v[24:27], v12, s[24:27], 0 offen
    buffer_load_dwordx4 v[28:31], v12, s[24:27], 0 offen offset:16
    v_mfma_f32_16x16x32_bf16 v[224:227], v[64:67], v[96:99], 0
    s_add_u32 s37, s36, s33
    s_add_u32 s34, s34, 128
    v_mfma_f32_16x16x32_bf16 v[228:231], v[68:71], v[96:99], 0
    s_add_u32 s35, s35, 393216
    s_add_u32 s40, s36, 57344
    s_sub_u32 s36, s40, 163840
    s_cselect_b32 s36, s40, s36
    v_mfma_f32_16x16x32_bf16 v[232:235], v[72:75], v[96:99], 0
    v_add_u32 v7, s36, v5
    v_xor_b32 v48, 32, v7
    v_mfma_f32_16x16x32_bf16 v[236:239], v[76:79], v[96:99], 0
    s_add_u32 s40, s36, 8192
    s_sub_u32 s41, s40, 163840
    s_cselect_b32 s41, s40, s41
    v_add_u32 v8, s41, v5
    v_xor_b32 v49, 32, v8
    v_mfma_f32_16x16x32_bf16 v[240:243], v[64:67], v[100:103], 0
    s_add_u32 s40, s36, 16384
    s_sub_u32 s41, s40, 163840
    s_cselect_b32 s41, s40, s41
    v_add_u32 v9, s41, v5
    v_mfma_f32_16x16x32_bf16 v[244:247], v[68:71], v[100:103], 0
    v_xor_b32 v50, 32, v9
    s_add_u32 s40, s36, s44
    s_sub_u32 s41, s40, 163840
    s_cselect_b32 s41, s40, s41
    v_add_u32 v11, s41, v4
    v_mfma_f32_16x16x32_bf16 v[248:251], v[72:75], v[100:103], 0
    v_mov_b32 v6, v11
    v_mfma_f32_16x16x32_bf16 v[252:255], v[76:79], v[100:103], 0
    s_waitcnt vmcnt(10) lgkmcnt(0)
    s_barrier
    v_mfma_f32_16x16x32_bf16 v[160:163], v[120:123], v[104:107], v[160:163]
    ds_read_b64_tr_b16 v[80:81], v7 offset:0
    s_setprio 3
    s_add_u32 s42, s37, 0
    v_mfma_f32_16x16x32_bf16 v[164:167], v[120:123], v[108:111], v[164:167]
    ds_read_b64_tr_b16 v[82:83], v7 offset:512
    s_sub_u32 m0, s42, 163840
    s_cselect_b32 m0, s42, m0
    v_mfma_f32_16x16x32_bf16 v[168:171], v[120:123], v[112:115], v[168:171]
    ds_read_b128 v[64:67], v6 offset:0
    s_add_u32 s43, s34, 393088
    v_mfma_f32_16x16x32_bf16 v[172:175], v[120:123], v[116:119], v[172:175]
    ds_read_b128 v[68:71], v6 offset:2048
    buffer_load_dwordx4 v2, s[8:11], s43 offen lds
    v_mfma_f32_16x16x32_bf16 v[176:179], v[124:127], v[104:107], v[176:179]
    ds_read_b128 v[72:75], v6 offset:4096
    v_mfma_f32_16x16x32_bf16 v[180:183], v[124:127], v[108:111], v[180:183]
    ds_read_b128 v[76:79], v6 offset:6144
    s_add_u32 s42, s37, 8192
    v_mfma_f32_16x16x32_bf16 v[184:187], v[124:127], v[112:115], v[184:187]
    ds_read_b64_tr_b16 v[84:85], v48 offset:0
    s_sub_u32 m0, s42, 163840
    s_cselect_b32 m0, s42, m0
    v_mfma_f32_16x16x32_bf16 v[188:191], v[124:127], v[116:119], v[188:191]
    ds_read_b64_tr_b16 v[86:87], v48 offset:512
    s_add_u32 s43, s35, 0
    v_mfma_f32_16x16x32_bf16 v[192:195], v[128:131], v[104:107], v[192:195]
    ds_read_b64_tr_b16 v[88:89], v8 offset:0
    buffer_load_dwordx4 v3, s[12:15], s43 offen lds
    v_mfma_f32_16x16x32_bf16 v[196:199], v[128:131], v[108:111], v[196:199]
    ds_read_b64_tr_b16 v[90:91], v8 offset:512
    v_mfma_f32_16x16x32_bf16 v[200:203], v[128:131], v[112:115], v[200:203]
    ds_read_b64_tr_b16 v[92:93], v49 offset:0
    s_add_u32 s42, s37, 16384
    v_mfma_f32_16x16x32_bf16 v[204:207], v[128:131], v[116:119], v[204:207]
    ds_read_b64_tr_b16 v[94:95], v49 offset:512
    s_sub_u32 m0, s42, 163840
    s_cselect_b32 m0, s42, m0
    v_mfma_f32_16x16x32_bf16 v[208:211], v[132:135], v[104:107], v[208:211]
    ds_read_b64_tr_b16 v[96:97], v9 offset:0
    s_setprio 2
    s_add_u32 s43, s35, 2048
    v_mfma_f32_16x16x32_bf16 v[212:215], v[132:135], v[108:111], v[212:215]
    ds_read_b64_tr_b16 v[98:99], v9 offset:512
    buffer_load_dwordx4 v3, s[12:15], s43 offen lds
    v_mfma_f32_16x16x32_bf16 v[216:219], v[132:135], v[112:115], v[216:219]
    ds_read_b64_tr_b16 v[100:101], v50 offset:0
    v_mfma_f32_16x16x32_bf16 v[220:223], v[132:135], v[116:119], v[220:223]
    ds_read_b64_tr_b16 v[102:103], v50 offset:512
    s_add_u32 s42, s37, 24576
    v_mfma_f32_16x16x32_bf16 v[224:227], v[104:107], v[136:139], v[224:227]
    s_sub_u32 m0, s42, 163840
    s_cselect_b32 m0, s42, m0
    v_mfma_f32_16x16x32_bf16 v[228:231], v[108:111], v[136:139], v[228:231]
    s_add_u32 s43, s35, 4096
    v_mfma_f32_16x16x32_bf16 v[232:235], v[112:115], v[136:139], v[232:235]
    buffer_load_dwordx4 v3, s[12:15], s43 offen lds
    v_mfma_f32_16x16x32_bf16 v[236:239], v[116:119], v[136:139], v[236:239]
    v_mfma_f32_16x16x32_bf16 v[240:243], v[104:107], v[140:143], v[240:243]
    buffer_load_dwordx4 v[36:39], v10, s[12:15], s47 offen
    s_add_u32 s47, s47, 1048576
    v_mfma_f32_16x16x32_bf16 v[244:247], v[108:111], v[140:143], v[244:247]
    v_mfma_f32_16x16x32_bf16 v[248:251], v[112:115], v[140:143], v[248:251]
    v_xor_b32 v6, 64, v11
    v_mfma_f32_16x16x32_bf16 v[252:255], v[116:119], v[140:143], v[252:255]
    s_mov_b32 s38, 12
.p2align 6
L_gemm_2:
    s_waitcnt lgkmcnt(0)
    v_mfma_f32_16x16x32_bf16 v[160:163], v[80:83], v[64:67], v[160:163]
    ds_read_b64_tr_b16 v[120:121], v7 offset:4096
    s_setprio 1
    v_mfma_f32_16x16x32_bf16 v[164:167], v[80:83], v[68:71], v[164:167]
    ds_read_b64_tr_b16 v[122:123], v7 offset:4608
    s_add_u32 s42, s37, 32768
    v_mfma_f32_16x16x32_bf16 v[168:171], v[80:83], v[72:75], v[168:171]
    ds_read_b128 v[104:107], v6 offset:0
    s_sub_u32 m0, s42, 163840
    s_cselect_b32 m0, s42, m0
    v_mfma_f32_16x16x32_bf16 v[172:175], v[80:83], v[76:79], v[172:175]
    ds_read_b128 v[108:111], v6 offset:2048
    s_add_u32 s43, s34, 0
    v_mfma_f32_16x16x32_bf16 v[176:179], v[84:87], v[64:67], v[176:179]
    ds_read_b128 v[112:115], v6 offset:4096
    buffer_load_dwordx4 v2, s[8:11], s43 offen lds
    v_mfma_f32_16x16x32_bf16 v[180:183], v[84:87], v[68:71], v[180:183]
    ds_read_b128 v[116:119], v6 offset:6144
    v_mfma_f32_16x16x32_bf16 v[184:187], v[84:87], v[72:75], v[184:187]
    ds_read_b64_tr_b16 v[124:125], v48 offset:4096
    s_add_u32 s42, s37, 40960
    v_mfma_f32_16x16x32_bf16 v[188:191], v[84:87], v[76:79], v[188:191]
    ds_read_b64_tr_b16 v[126:127], v48 offset:4608
    s_sub_u32 m0, s42, 163840
    s_cselect_b32 m0, s42, m0
    v_mfma_f32_16x16x32_bf16 v[192:195], v[88:91], v[64:67], v[192:195]
    ds_read_b64_tr_b16 v[128:129], v8 offset:4096
    s_add_u32 s43, s34, 131072
    v_mfma_f32_16x16x32_bf16 v[196:199], v[88:91], v[68:71], v[196:199]
    ds_read_b64_tr_b16 v[130:131], v8 offset:4608
    buffer_load_dwordx4 v2, s[8:11], s43 offen lds
    v_mfma_f32_16x16x32_bf16 v[200:203], v[88:91], v[72:75], v[200:203]
    ds_read_b64_tr_b16 v[132:133], v49 offset:4096
    v_mfma_f32_16x16x32_bf16 v[204:207], v[88:91], v[76:79], v[204:207]
    ds_read_b64_tr_b16 v[134:135], v49 offset:4608
    s_add_u32 s42, s37, 49152
    v_mfma_f32_16x16x32_bf16 v[208:211], v[92:95], v[64:67], v[208:211]
    ds_read_b64_tr_b16 v[136:137], v9 offset:4096
    s_setprio 0
    s_sub_u32 m0, s42, 163840
    s_cselect_b32 m0, s42, m0
    v_mfma_f32_16x16x32_bf16 v[212:215], v[92:95], v[68:71], v[212:215]
    ds_read_b64_tr_b16 v[138:139], v9 offset:4608
    s_add_u32 s43, s34, 262144
    v_mfma_f32_16x16x32_bf16 v[216:219], v[92:95], v[72:75], v[216:219]
    ds_read_b64_tr_b16 v[140:141], v50 offset:4096
    buffer_load_dwordx4 v2, s[8:11], s43 offen lds
    v_mfma_f32_16x16x32_bf16 v[220:223], v[92:95], v[76:79], v[220:223]
    ds_read_b64_tr_b16 v[142:143], v50 offset:4608
    v_mfma_f32_16x16x32_bf16 v[224:227], v[64:67], v[96:99], v[224:227]
    s_add_u32 s37, s36, s33
    s_add_u32 s34, s34, 128
    v_mfma_f32_16x16x32_bf16 v[228:231], v[68:71], v[96:99], v[228:231]
    s_add_u32 s35, s35, 393216
    s_add_u32 s40, s36, 57344
    s_sub_u32 s36, s40, 163840
    s_cselect_b32 s36, s40, s36
    v_mfma_f32_16x16x32_bf16 v[232:235], v[72:75], v[96:99], v[232:235]
    v_add_u32 v7, s36, v5
    v_xor_b32 v48, 32, v7
    v_mfma_f32_16x16x32_bf16 v[236:239], v[76:79], v[96:99], v[236:239]
    s_add_u32 s40, s36, 8192
    s_sub_u32 s41, s40, 163840
    s_cselect_b32 s41, s40, s41
    v_add_u32 v8, s41, v5
    v_xor_b32 v49, 32, v8
    v_mfma_f32_16x16x32_bf16 v[240:243], v[64:67], v[100:103], v[240:243]
    s_add_u32 s40, s36, 16384
    s_sub_u32 s41, s40, 163840
    s_cselect_b32 s41, s40, s41
    v_add_u32 v9, s41, v5
    v_mfma_f32_16x16x32_bf16 v[244:247], v[68:71], v[100:103], v[244:247]
    v_xor_b32 v50, 32, v9
    s_add_u32 s40, s36, s44
    s_sub_u32 s41, s40, 163840
    s_cselect_b32 s41, s40, s41
    v_add_u32 v11, s41, v4
    v_mfma_f32_16x16x32_bf16 v[248:251], v[72:75], v[100:103], v[248:251]
    v_mov_b32 v6, v11
    v_mfma_f32_16x16x32_bf16 v[252:255], v[76:79], v[100:103], v[252:255]
    s_waitcnt vmcnt(7) lgkmcnt(0)
    s_barrier
    v_mfma_f32_16x16x32_bf16 v[160:163], v[120:123], v[104:107], v[160:163]
    ds_read_b64_tr_b16 v[80:81], v7 offset:0
    s_setprio 3
    s_add_u32 s42, s37, 0
    v_mfma_f32_16x16x32_bf16 v[164:167], v[120:123], v[108:111], v[164:167]
    ds_read_b64_tr_b16 v[82:83], v7 offset:512
    s_sub_u32 m0, s42, 163840
    s_cselect_b32 m0, s42, m0
    v_mfma_f32_16x16x32_bf16 v[168:171], v[120:123], v[112:115], v[168:171]
    ds_read_b128 v[64:67], v6 offset:0
    s_add_u32 s43, s34, 393088
    v_mfma_f32_16x16x32_bf16 v[172:175], v[120:123], v[116:119], v[172:175]
    ds_read_b128 v[68:71], v6 offset:2048
    buffer_load_dwordx4 v2, s[8:11], s43 offen lds
    v_mfma_f32_16x16x32_bf16 v[176:179], v[124:127], v[104:107], v[176:179]
    ds_read_b128 v[72:75], v6 offset:4096
    v_mfma_f32_16x16x32_bf16 v[180:183], v[124:127], v[108:111], v[180:183]
    ds_read_b128 v[76:79], v6 offset:6144
    s_add_u32 s42, s37, 8192
    v_mfma_f32_16x16x32_bf16 v[184:187], v[124:127], v[112:115], v[184:187]
    ds_read_b64_tr_b16 v[84:85], v48 offset:0
    s_sub_u32 m0, s42, 163840
    s_cselect_b32 m0, s42, m0
    v_mfma_f32_16x16x32_bf16 v[188:191], v[124:127], v[116:119], v[188:191]
    ds_read_b64_tr_b16 v[86:87], v48 offset:512
    s_add_u32 s43, s35, 0
    v_mfma_f32_16x16x32_bf16 v[192:195], v[128:131], v[104:107], v[192:195]
    ds_read_b64_tr_b16 v[88:89], v8 offset:0
    buffer_load_dwordx4 v3, s[12:15], s43 offen lds
    v_mfma_f32_16x16x32_bf16 v[196:199], v[128:131], v[108:111], v[196:199]
    ds_read_b64_tr_b16 v[90:91], v8 offset:512
    v_mfma_f32_16x16x32_bf16 v[200:203], v[128:131], v[112:115], v[200:203]
    ds_read_b64_tr_b16 v[92:93], v49 offset:0
    s_add_u32 s42, s37, 16384
    v_mfma_f32_16x16x32_bf16 v[204:207], v[128:131], v[116:119], v[204:207]
    ds_read_b64_tr_b16 v[94:95], v49 offset:512
    s_sub_u32 m0, s42, 163840
    s_cselect_b32 m0, s42, m0
    v_mfma_f32_16x16x32_bf16 v[208:211], v[132:135], v[104:107], v[208:211]
    ds_read_b64_tr_b16 v[96:97], v9 offset:0
    s_setprio 2
    s_add_u32 s43, s35, 2048
    v_mfma_f32_16x16x32_bf16 v[212:215], v[132:135], v[108:111], v[212:215]
    ds_read_b64_tr_b16 v[98:99], v9 offset:512
    buffer_load_dwordx4 v3, s[12:15], s43 offen lds
    v_mfma_f32_16x16x32_bf16 v[216:219], v[132:135], v[112:115], v[216:219]
    ds_read_b64_tr_b16 v[100:101], v50 offset:0
    v_mfma_f32_16x16x32_bf16 v[220:223], v[132:135], v[116:119], v[220:223]
    ds_read_b64_tr_b16 v[102:103], v50 offset:512
    s_add_u32 s42, s37, 24576
    v_mfma_f32_16x16x32_bf16 v[224:227], v[104:107], v[136:139], v[224:227]
    s_sub_u32 m0, s42, 163840
    s_cselect_b32 m0, s42, m0
    v_mfma_f32_16x16x32_bf16 v[228:231], v[108:111], v[136:139], v[228:231]
    s_add_u32 s43, s35, 4096
    v_mfma_f32_16x16x32_bf16 v[232:235], v[112:115], v[136:139], v[232:235]
    buffer_load_dwordx4 v3, s[12:15], s43 offen lds
    v_mfma_f32_16x16x32_bf16 v[236:239], v[116:119], v[136:139], v[236:239]
    v_mfma_f32_16x16x32_bf16 v[240:243], v[104:107], v[140:143], v[240:243]
    buffer_load_dwordx4 v[36:39], v10, s[12:15], s47 offen
    s_add_u32 s47, s47, 1048576
    v_mfma_f32_16x16x32_bf16 v[244:247], v[108:111], v[140:143], v[244:247]
    v_mfma_f32_16x16x32_bf16 v[248:251], v[112:115], v[140:143], v[248:251]
    v_xor_b32 v6, 64, v11
    v_mfma_f32_16x16x32_bf16 v[252:255], v[116:119], v[140:143], v[252:255]
    s_cmp_eq_u32 s38, s67
    s_cbranch_scc0 L_nd_4
    v_mov_b32 v12, 1
    s_mov_b64 exec, 1
    buffer_atomic_add v12, off, s[20:23], s53 sc1
    s_mov_b64 exec, -1
    s_nop 3
L_nd_4:
    s_cmp_eq_u32 s38, s66
    s_cbranch_scc0 L_nc_3
    v_lshlrev_b32 v12, 2, v0
    buffer_load_dword v15, v12, s[20:23], 0 offen sc1
L_nc_3:
    s_sub_u32 s38, s38, 1
    s_cmp_lg_u32 s38, 0
    s_cbranch_scc1 L_gemm_2
    s_waitcnt lgkmcnt(0)
    v_mfma_f32_16x16x32_bf16 v[160:163], v[80:83], v[64:67], v[160:163]
    ds_read_b64_tr_b16 v[120:121], v7 offset:4096
    s_setprio 1
    v_mfma_f32_16x16x32_bf16 v[164:167], v[80:83], v[68:71], v[164:167]
    ds_read_b64_tr_b16 v[122:123], v7 offset:4608
    s_add_u32 s42, s37, 32768
    v_mfma_f32_16x16x32_bf16 v[168:171], v[80:83], v[72:75], v[168:171]
    ds_read_b128 v[104:107], v6 offset:0
    s_sub_u32 m0, s42, 163840
    s_cselect_b32 m0, s42, m0
    v_mfma_f32_16x16x32_bf16 v[172:175], v[80:83], v[76:79], v[172:175]
    ds_read_b128 v[108:111], v6 offset:2048
    s_add_u32 s43, s34, 0
    v_mfma_f32_16x16x32_bf16 v[176:179], v[84:87], v[64:67], v[176:179]
    ds_read_b128 v[112:115], v6 offset:4096
    buffer_load_dwordx4 v2, s[8:11], s43 offen lds
    v_mfma_f32_16x16x32_bf16 v[180:183], v[84:87], v[68:71], v[180:183]
    ds_read_b128 v[116:119], v6 offset:6144
    v_mfma_f32_16x16x32_bf16 v[184:187], v[84:87], v[72:75], v[184:187]
    ds_read_b64_tr_b16 v[124:125], v48 offset:4096
    s_add_u32 s42, s37, 40960
    v_mfma_f32_16x16x32_bf16 v[188:191], v[84:87], v[76:79], v[188:191]
    ds_read_b64_tr_b16 v[126:127], v48 offset:4608
    s_sub_u32 m0, s42, 163840
    s_cselect_b32 m0, s42, m0
    v_mfma_f32_16x16x32_bf16 v[192:195], v[88:91], v[64:67], v[192:195]
    ds_read_b64_tr_b16 v[128:129], v8 offset:4096
    s_add_u32 s43, s34, 131072
    v_mfma_f32_16x16x32_bf16 v[196:199], v[88:91], v[68:71], v[196:199]
    ds_read_b64_tr_b16 v[130:131], v8 offset:4608
    buffer_load_dwordx4 v2, s[8:11], s43 offen lds
    v_mfma_f32_16x16x32_bf16 v[200:203], v[88:91], v[72:75], v[200:203]
    ds_read_b64_tr_b16 v[132:133], v49 offset:4096
    v_mfma_f32_16x16x32_bf16 v[204:207], v[88:91], v[76:79], v[204:207]
    ds_read_b64_tr_b16 v[134:135], v49 offset:4608
    s_add_u32 s42, s37, 49152
    v_mfma_f32_16x16x32_bf16 v[208:211], v[92:95], v[64:67], v[208:211]
    ds_read_b64_tr_b16 v[136:137], v9 offset:4096
    s_setprio 0
    s_sub_u32 m0, s42, 163840
    s_cselect_b32 m0, s42, m0
    v_mfma_f32_16x16x32_bf16 v[212:215], v[92:95], v[68:71], v[212:215]
    ds_read_b64_tr_b16 v[138:139], v9 offset:4608
    s_add_u32 s43, s34, 262144
    v_mfma_f32_16x16x32_bf16 v[216:219], v[92:95], v[72:75], v[216:219]
    ds_read_b64_tr_b16 v[140:141], v50 offset:4096
    buffer_load_dwordx4 v2, s[8:11], s43 offen lds
    v_mfma_f32_16x16x32_bf16 v[220:223], v[92:95], v[76:79], v[220:223]
    ds_read_b64_tr_b16 v[142:143], v50 offset:4608
    v_mfma_f32_16x16x32_bf16 v[224:227], v[64:67], v[96:99], v[224:227]
    s_add_u32 s37, s36, s33
    s_add_u32 s34, s34, 128
    v_mfma_f32_16x16x32_bf16 v[228:231], v[68:71], v[96:99], v[228:231]
    s_add_u32 s35, s35, 393216
    s_add_u32 s40, s36, 57344
    s_sub_u32 s36, s40, 163840
    s_cselect_b32 s36, s40, s36
    v_mfma_f32_16x16x32_bf16 v[232:235], v[72:75], v[96:99], v[232:235]
    v_add_u32 v7, s36, v5
    v_xor_b32 v48, 32, v7
    v_mfma_f32_16x16x32_bf16 v[236:239], v[76:79], v[96:99], v[236:239]
    s_add_u32 s40, s36, 8192
    s_sub_u32 s41, s40, 163840
    s_cselect_b32 s41, s40, s41
    v_add_u32 v8, s41, v5
    v_xor_b32 v49, 32, v8
    v_mfma_f32_16x16x32_bf16 v[240:243], v[64:67], v[100:103], v[240:243]
    s_add_u32 s40, s36, 16384
    s_sub_u32 s41, s40, 163840
    s_cselect_b32 s41, s40, s41
    v_add_u32 v9, s41, v5
    v_mfma_f32_16x16x32_bf16 v[244:247], v[68:71], v[100:103], v[244:247]
    v_xor_b32 v50, 32, v9
    s_add_u32 s40, s36, s44
    s_sub_u32 s41, s40, 163840
    s_cselect_b32 s41, s40, s41
    v_add_u32 v11, s41, v4
    v_mfma_f32_16x16x32_bf16 v[248:251], v[72:75], v[100:103], v[248:251]
    v_mov_b32 v6, v11
    v_mfma_f32_16x16x32_bf16 v[252:255], v[76:79], v[100:103], v[252:255]
    s_waitcnt vmcnt(7) lgkmcnt(0)
    s_barrier
    v_mfma_f32_16x16x32_bf16 v[160:163], v[120:123], v[104:107], v[160:163]
    ds_read_b64_tr_b16 v[80:81], v7 offset:0
    s_setprio 3
    s_add_u32 s42, s37, 0
    v_mfma_f32_16x16x32_bf16 v[164:167], v[120:123], v[108:111], v[164:167]
    ds_read_b64_tr_b16 v[82:83], v7 offset:512
    s_sub_u32 m0, s42, 163840
    s_cselect_b32 m0, s42, m0
    v_mfma_f32_16x16x32_bf16 v[168:171], v[120:123], v[112:115], v[168:171]
    ds_read_b128 v[64:67], v6 offset:0
    s_add_u32 s43, s34, 393088
    v_mfma_f32_16x16x32_bf16 v[172:175], v[120:123], v[116:119], v[172:175]
    ds_read_b128 v[68:71], v6 offset:2048
    buffer_load_dwordx4 v2, s[8:11], s43 offen lds
    v_mfma_f32_16x16x32_bf16 v[176:179], v[124:127], v[104:107], v[176:179]
    ds_read_b128 v[72:75], v6 offset:4096
    v_mfma_f32_16x16x32_bf16 v[180:183], v[124:127], v[108:111], v[180:183]
    ds_read_b128 v[76:79], v6 offset:6144
    v_mfma_f32_16x16x32_bf16 v[184:187], v[124:127], v[112:115], v[184:187]
    ds_read_b64_tr_b16 v[84:85], v48 offset:0
    v_mfma_f32_16x16x32_bf16 v[188:191], v[124:127], v[116:119], v[188:191]
    ds_read_b64_tr_b16 v[86:87], v48 offset:512
    v_mfma_f32_16x16x32_bf16 v[192:195], v[128:131], v[104:107], v[192:195]
    ds_read_b64_tr_b16 v[88:89], v8 offset:0
    v_mfma_f32_16x16x32_bf16 v[196:199], v[128:131], v[108:111], v[196:199]
    ds_read_b64_tr_b16 v[90:91], v8 offset:512
    v_mfma_f32_16x16x32_bf16 v[200:203], v[128:131], v[112:115], v[200:203]
    ds_read_b64_tr_b16 v[92:93], v49 offset:0
    v_mfma_f32_16x16x32_bf16 v[204:207], v[128:131], v[116:119], v[204:207]
    ds_read_b64_tr_b16 v[94:95], v49 offset:512
    v_mfma_f32_16x16x32_bf16 v[208:211], v[132:135], v[104:107], v[208:211]
    ds_read_b64_tr_b16 v[96:97], v9 offset:0
    s_setprio 2
    v_mfma_f32_16x16x32_bf16 v[212:215], v[132:135], v[108:111], v[212:215]
    ds_read_b64_tr_b16 v[98:99], v9 offset:512
    v_mfma_f32_16x16x32_bf16 v[216:219], v[132:135], v[112:115], v[216:219]
    ds_read_b64_tr_b16 v[100:101], v50 offset:0
    v_mfma_f32_16x16x32_bf16 v[220:223], v[132:135], v[116:119], v[220:223]
    ds_read_b64_tr_b16 v[102:103], v50 offset:512
    v_mfma_f32_16x16x32_bf16 v[224:227], v[104:107], v[136:139], v[224:227]
    v_mfma_f32_16x16x32_bf16 v[228:231], v[108:111], v[136:139], v[228:231]
    v_mfma_f32_16x16x32_bf16 v[232:235], v[112:115], v[136:139], v[232:235]
    v_mfma_f32_16x16x32_bf16 v[236:239], v[116:119], v[136:139], v[236:239]
    v_mfma_f32_16x16x32_bf16 v[240:243], v[104:107], v[140:143], v[240:243]
    v_mfma_f32_16x16x32_bf16 v[244:247], v[108:111], v[140:143], v[244:247]
    v_mfma_f32_16x16x32_bf16 v[248:251], v[112:115], v[140:143], v[248:251]
    v_xor_b32 v6, 64, v11
    v_mfma_f32_16x16x32_bf16 v[252:255], v[116:119], v[140:143], v[252:255]
    s_waitcnt lgkmcnt(0)
    v_mfma_f32_16x16x32_bf16 v[160:163], v[80:83], v[64:67], v[160:163]
    ds_read_b64_tr_b16 v[120:121], v7 offset:4096
    s_setprio 1
    v_mov_b32 v12, 0
    v_lshlrev_b32 v13, 16, v16
    v_and_b32 v14, 0xffff0000, v16
    v_lshlrev_b32 v32, 16, v24
    v_and_b32 v1, 0xffff0000, v24
    v_mul_f32 v13, v13, v32
    v_mul_f32 v14, v14, v1
    v_mfma_f32_16x16x32_bf16 v[164:167], v[80:83], v[68:71], v[164:167]
    ds_read_b64_tr_b16 v[122:123], v7 offset:4608
    v_cvt_pk_bf16_f32 v13, v13, v14
    v_lshlrev_b32 v14, 16, v13
    v_and_b32 v13, 0xffff0000, v13
    v_add_f32 v12, v12, v14
    v_add_f32 v12, v12, v13
    v_lshlrev_b32 v13, 16, v17
    v_mfma_f32_16x16x32_bf16 v[168:171], v[80:83], v[72:75], v[168:171]
    ds_read_b128 v[104:107], v6 offset:0
    v_and_b32 v14, 0xffff0000, v17
    v_lshlrev_b32 v32, 16, v25
    v_and_b32 v1, 0xffff0000, v25
    v_mul_f32 v13, v13, v32
    v_mul_f32 v14, v14, v1
    v_cvt_pk_bf16_f32 v13, v13, v14
    v_lshlrev_b32 v14, 16, v13
    v_mfma_f32_16x16x32_bf16 v[172:175], v[80:83], v[76:79], v[172:175]
    ds_read_b128 v[108:111], v6 offset:2048
    v_and_b32 v13, 0xffff0000, v13
    v_add_f32 v12, v12, v14
    v_add_f32 v12, v12, v13
    v_lshlrev_b32 v13, 16, v18
    v_and_b32 v14, 0xffff0000, v18
    v_lshlrev_b32 v32, 16, v26
    v_mfma_f32_16x16x32_bf16 v[176:179], v[84:87], v[64:67], v[176:179]
    ds_read_b128 v[112:115], v6 offset:4096
    v_and_b32 v1, 0xffff0000, v26
    v_mul_f32 v13, v13, v32
    v_mul_f32 v14, v14, v1
    v_cvt_pk_bf16_f32 v13, v13, v14
    v_lshlrev_b32 v14, 16, v13
    v_and_b32 v13, 0xffff0000, v13
    v_mfma_f32_16x16x32_bf16 v[180:183], v[84:87], v[68:71], v[180:183]
    ds_read_b128 v[116:119], v6 offset:6144
    v_add_f32 v12, v12, v14
    v_add_f32 v12, v12, v13
    v_lshlrev_b32 v13, 16, v19
    v_and_b32 v14, 0xffff0000, v19
    v_lshlrev_b32 v32, 16, v27
    v_and_b32 v1, 0xffff0000, v27
    v_mul_f32 v13, v13, v32
    v_mfma_f32_16x16x32_bf16 v[184:187], v[84:87], v[72:75], v[184:187]
    ds_read_b64_tr_b16 v[124:125], v48 offset:4096
    v_mul_f32 v14, v14, v1
    v_cvt_pk_bf16_f32 v13, v13, v14
    v_lshlrev_b32 v14, 16, v13
    v_and_b32 v13, 0xffff0000, v13
    v_add_f32 v12, v12, v14
    v_add_f32 v12, v12, v13
    v_mfma_f32_16x16x32_bf16 v[188:191], v[84:87], v[76:79], v[188:191]
    ds_read_b64_tr_b16 v[126:127], v48 offset:4608
    v_lshlrev_b32 v13, 16, v20
    v_and_b32 v14, 0xffff0000, v20
    v_lshlrev_b32 v32, 16, v28
    v_and_b32 v1, 0xffff0000, v28
    v_mul_f32 v13, v13, v32
    v_mul_f32 v14, v14, v1
    v_mfma_f32_16x16x32_bf16 v[192:195], v[88:91], v[64:67], v[192:195]
    ds_read_b64_tr_b16 v[128:129], v8 offset:4096
    v_cvt_pk_bf16_f32 v13, v13, v14
    v_lshlrev_b32 v14, 16, v13
    v_and_b32 v13, 0xffff0000, v13
    v_add_f32 v12, v12, v14
    v_add_f32 v12, v12, v13
    v_lshlrev_b32 v13, 16, v21
    v_and_b32 v14, 0xffff0000, v21
    v_mfma_f32_16x16x32_bf16 v[196:199], v[88:91], v[68:71], v[196:199]
    ds_read_b64_tr_b16 v[130:131], v8 offset:4608
    v_lshlrev_b32 v32, 16, v29
    v_and_b32 v1, 0xffff0000, v29
    v_mul_f32 v13, v13, v32
    v_mul_f32 v14, v14, v1
    v_cvt_pk_bf16_f32 v13, v13, v14
    v_lshlrev_b32 v14, 16, v13
    v_mfma_f32_16x16x32_bf16 v[200:203], v[88:91], v[72:75], v[200:203]
    ds_read_b64_tr_b16 v[132:133], v49 offset:4096
    v_and_b32 v13, 0xffff0000, v13
    v_add_f32 v12, v12, v14
    v_add_f32 v12, v12, v13
    v_lshlrev_b32 v13, 16, v22
    v_and_b32 v14, 0xffff0000, v22
    v_lshlrev_b32 v32, 16, v30
    v_and_b32 v1, 0xffff0000, v30
    v_mfma_f32_16x16x32_bf16 v[204:207], v[88:91], v[76:79], v[204:207]
    ds_read_b64_tr_b16 v[134:135], v49 offset:4608
    v_mul_f32 v13, v13, v32
    v_mul_f32 v14, v14, v1
    v_cvt_pk_bf16_f32 v13, v13, v14
    v_lshlrev_b32 v14, 16, v13
    v_and_b32 v13, 0xffff0000, v13
    v_add_f32 v12, v12, v14
    v_mfma_f32_16x16x32_bf16 v[208:211], v[92:95], v[64:67], v[208:211]
    ds_read_b64_tr_b16 v[136:137], v9 offset:4096
    s_setprio 0
    v_add_f32 v12, v12, v13
    v_lshlrev_b32 v13, 16, v23
    v_and_b32 v14, 0xffff0000, v23
    v_lshlrev_b32 v32, 16, v31
    v_and_b32 v1, 0xffff0000, v31
    v_mul_f32 v13, v13, v32
    v_mfma_f32_16x16x32_bf16 v[212:215], v[92:95], v[68:71], v[212:215]
    ds_read_b64_tr_b16 v[138:139], v9 offset:4608
    v_mul_f32 v14, v14, v1
    v_cvt_pk_bf16_f32 v13, v13, v14
    v_lshlrev_b32 v14, 16, v13
    v_and_b32 v13, 0xffff0000, v13
    v_add_f32 v12, v12, v14
    v_add_f32 v12, v12, v13
    s_nop 1
    v_add_f32_dpp v12, v12, v12 row_shr:1 row_mask:0xf bank_mask:0xf bound_ctrl:0
    v_mfma_f32_16x16x32_bf16 v[216:219], v[92:95], v[72:75], v[216:219]
    ds_read_b64_tr_b16 v[140:141], v50 offset:4096
    s_nop 1
    v_add_f32_dpp v12, v12, v12 row_shr:2 row_mask:0xf bank_mask:0xf bound_ctrl:0
    s_nop 1
    v_add_f32_dpp v12, v12, v12 row_shr:4 row_mask:0xf bank_mask:0xf bound_ctrl:0
    s_nop 1
    v_add_f32_dpp v12, v12, v12 row_shr:8 row_mask:0xf bank_mask:0xf bound_ctrl:0
    s_nop 1
    v_add_f32_dpp v12, v12, v12 row_bcast:15 row_mask:0xa bank_mask:0xf
    s_nop 1
    v_add_f32_dpp v12, v12, v12 row_bcast:31 row_mask:0xc bank_mask:0xf
    s_nop 1
    v_cvt_pk_bf16_f32 v12, v12, v12
    v_mfma_f32_16x16x32_bf16 v[220:223], v[92:95], v[76:79], v[220:223]
    ds_read_b64_tr_b16 v[142:143], v50 offset:4608
    v_lshlrev_b32 v12, 16, v12
    v_mul_f32 v12, 0xbfb8aa3b, v12
    v_exp_f32 v12, v12
    s_nop 0
    v_add_f32 v12, 1.0, v12
    v_rcp_f32 v12, v12
    s_nop 0
    v_cvt_pk_bf16_f32 v12, v12, v12
    v_lshlrev_b32 v12, 16, v12
    v_mov_b32 v13, 25165824
    v_mfma_f32_16x16x32_bf16 v[224:227], v[64:67], v[96:99], v[224:227]
    s_add_u32 s37, s36, s33
    s_add_u32 s34, s34, 128
    v_mfma_f32_16x16x32_bf16 v[228:231], v[68:71], v[96:99], v[228:231]
    s_add_u32 s35, s35, 393216
    s_add_u32 s40, s36, 57344
    s_sub_u32 s36, s40, 163840
    s_cselect_b32 s36, s40, s36
    v_mfma_f32_16x16x32_bf16 v[232:235], v[72:75], v[96:99], v[232:235]
    v_add_u32 v7, s36, v5
    v_xor_b32 v48, 32, v7
    v_mfma_f32_16x16x32_bf16 v[236:239], v[76:79], v[96:99], v[236:239]
    s_add_u32 s40, s36, 8192
    s_sub_u32 s41, s40, 163840
    s_cselect_b32 s41, s40, s41
    v_add_u32 v8, s41, v5
    v_xor_b32 v49, 32, v8
    v_mfma_f32_16x16x32_bf16 v[240:243], v[64:67], v[100:103], v[240:243]
    s_add_u32 s40, s36, 16384
    s_sub_u32 s41, s40, 163840
    s_cselect_b32 s41, s40, s41
    v_add_u32 v9, s41, v5
    v_mfma_f32_16x16x32_bf16 v[244:247], v[68:71], v[100:103], v[244:247]
    v_xor_b32 v50, 32, v9
    s_add_u32 s40, s36, s44
    s_sub_u32 s41, s40, 163840
    s_cselect_b32 s41, s40, s41
    v_add_u32 v11, s41, v4
    v_mfma_f32_16x16x32_bf16 v[248:251], v[72:75], v[100:103], v[248:251]
    v_mov_b32 v6, v11
    v_mfma_f32_16x16x32_bf16 v[252:255], v[76:79], v[100:103], v[252:255]
    s_waitcnt vmcnt(0) lgkmcnt(0)
    s_barrier
    v_mfma_f32_16x16x32_bf16 v[160:163], v[120:123], v[104:107], v[160:163]
    ds_read_b64_tr_b16 v[80:81], v7 offset:0
    s_setprio 3
    v_mfma_f32_16x16x32_bf16 v[164:167], v[120:123], v[108:111], v[164:167]
    ds_read_b64_tr_b16 v[82:83], v7 offset:512
    v_mfma_f32_16x16x32_bf16 v[168:171], v[120:123], v[112:115], v[168:171]
    ds_read_b128 v[64:67], v6 offset:0
    v_mfma_f32_16x16x32_bf16 v[172:175], v[120:123], v[116:119], v[172:175]
    ds_read_b128 v[68:71], v6 offset:2048
    v_mfma_f32_16x16x32_bf16 v[176:179], v[124:127], v[104:107], v[176:179]
    ds_read_b128 v[72:75], v6 offset:4096
    v_mfma_f32_16x16x32_bf16 v[180:183], v[124:127], v[108:111], v[180:183]
    ds_read_b128 v[76:79], v6 offset:6144
    v_mfma_f32_16x16x32_bf16 v[184:187], v[124:127], v[112:115], v[184:187]
    ds_read_b64_tr_b16 v[84:85], v48 offset:0
    v_mfma_f32_16x16x32_bf16 v[188:191], v[124:127], v[116:119], v[188:191]
    ds_read_b64_tr_b16 v[86:87], v48 offset:512
    v_mfma_f32_16x16x32_bf16 v[192:195], v[128:131], v[104:107], v[192:195]
    ds_read_b64_tr_b16 v[88:89], v8 offset:0
    v_mfma_f32_16x16x32_bf16 v[196:199], v[128:131], v[108:111], v[196:199]
    ds_read_b64_tr_b16 v[90:91], v8 offset:512
    v_mfma_f32_16x16x32_bf16 v[200:203], v[128:131], v[112:115], v[200:203]
    ds_read_b64_tr_b16 v[92:93], v49 offset:0
    v_mfma_f32_16x16x32_bf16 v[204:207], v[128:131], v[116:119], v[204:207]
    ds_read_b64_tr_b16 v[94:95], v49 offset:512
    v_mfma_f32_16x16x32_bf16 v[208:211], v[132:135], v[104:107], v[208:211]
    ds_read_b64_tr_b16 v[96:97], v9 offset:0
    s_setprio 2
    v_mfma_f32_16x16x32_bf16 v[212:215], v[132:135], v[108:111], v[212:215]
    ds_read_b64_tr_b16 v[98:99], v9 offset:512
    v_mfma_f32_16x16x32_bf16 v[216:219], v[132:135], v[112:115], v[216:219]
    ds_read_b64_tr_b16 v[100:101], v50 offset:0
    v_mfma_f32_16x16x32_bf16 v[220:223], v[132:135], v[116:119], v[220:223]
    ds_read_b64_tr_b16 v[102:103], v50 offset:512
    v_mfma_f32_16x16x32_bf16 v[224:227], v[104:107], v[136:139], v[224:227]
    v_mfma_f32_16x16x32_bf16 v[228:231], v[108:111], v[136:139], v[228:231]
    v_mfma_f32_16x16x32_bf16 v[232:235], v[112:115], v[136:139], v[232:235]
    v_mfma_f32_16x16x32_bf16 v[236:239], v[116:119], v[136:139], v[236:239]
    v_mfma_f32_16x16x32_bf16 v[240:243], v[104:107], v[140:143], v[240:243]
    v_mfma_f32_16x16x32_bf16 v[244:247], v[108:111], v[140:143], v[244:247]
    v_mfma_f32_16x16x32_bf16 v[248:251], v[112:115], v[140:143], v[248:251]
    v_xor_b32 v6, 64, v11
    v_mfma_f32_16x16x32_bf16 v[252:255], v[116:119], v[140:143], v[252:255]
    s_mov_b32 exec_lo, 0
    s_mov_b32 exec_hi, 0x80000000
    buffer_store_dword v12, v13, s[16:19], s68 offen sc1
    s_mov_b64 exec, -1
    s_nop 3
    s_waitcnt lgkmcnt(0)
    v_mfma_f32_16x16x32_bf16 v[160:163], v[80:83], v[64:67], v[160:163]
    ds_read_b64_tr_b16 v[120:121], v7 offset:4096
    s_setprio 1
    v_bfe_u32 v12, v0, 2, 1
    v_and_b32 v13, 3, v0
    v_mov_b32 v14, 0x3f803f80
    v_cmp_gt_u32 vcc, 2, v13
    v_mfma_f32_16x16x32_bf16 v[164:167], v[80:83], v[68:71], v[164:167]
    ds_read_b64_tr_b16 v[122:123], v7 offset:4608
    v_cndmask_b32 v14, 0, v14, vcc
    v_cmp_eq_u32 vcc, 0, v12
    s_nop 1
    v_cndmask_b32 v144, 0, v14, vcc
    v_cndmask_b32 v146, v14, 0, vcc
    v_mfma_f32_16x16x32_bf16 v[168:171], v[80:83], v[72:75], v[168:171]
    ds_read_b128 v[104:107], v6 offset:0
    v_mov_b32 v145, v144
    v_mov_b32 v147, v146
    v_mov_b32 v14, 0x4444
    v_mov_b32 v12, 0xeeee
    v_mfma_f32_16x16x32_bf16 v[172:175], v[80:83], v[76:79], v[172:175]
    ds_read_b128 v[108:111], v6 offset:2048
    v_mfma_f32_16x16x32_bf16 v[176:179], v[84:87], v[64:67], v[176:179]
    ds_read_b128 v[112:115], v6 offset:4096
    v_cmp_eq_u32 vcc, 1, v13
    s_nop 1
    v_cndmask_b32 v148, v14, v12, vcc
    v_mfma_f32_16x16x32_bf16 v[180:183], v[84:87], v[68:71], v[180:183]
    ds_read_b128 v[116:119], v6 offset:6144
    s_lshl_b32 s41, s31, 1
    s_add_u32 s41, s41, s29
    s_lshl_b32 s45, s41, 18
    v_mfma_f32_16x16x32_bf16 v[184:187], v[84:87], v[72:75], v[184:187]
    ds_read_b64_tr_b16 v[124:125], v48 offset:4096
    s_lshl_b32 s41, s32, 15
    s_lshl_b32 s40, s30, 13
    s_add_u32 s41, s41, s40
    s_add_u32 s35, s41, s45
    v_mfma_f32_16x16x32_bf16 v[188:191], v[84:87], v[76:79], v[188:191]
    ds_read_b64_tr_b16 v[126:127], v48 offset:4608
    v_mfma_f32_16x16x32_bf16 v[192:195], v[88:91], v[64:67], v[192:195]
    ds_read_b64_tr_b16 v[128:129], v8 offset:4096
    s_lshl_b32 s40, s29, 14
    s_lshl_b32 s41, s30, 12
    s_add_u32 s55, s40, s41
    s_add_u32 s45, s45, s41
    v_mfma_f32_16x16x32_bf16 v[196:199], v[88:91], v[68:71], v[196:199]
    ds_read_b64_tr_b16 v[130:131], v8 offset:4608
    s_lshl_b32 s39, s32, 1
    s_add_u32 s39, s39, 2
    s_and_b32 s39, s39, 15
    s_lshl_b32 s39, s39, 14
    v_mfma_f32_16x16x32_bf16 v[200:203], v[88:91], v[72:75], v[200:203]
    ds_read_b64_tr_b16 v[132:133], v49 offset:4096
    s_mov_b32 s46, 65536
    s_mov_b32 s38, 0
    s_lshl_b32 s101, s61, 7
    v_mfma_f32_16x16x32_bf16 v[204:207], v[88:91], v[76:79], v[204:207]
    ds_read_b64_tr_b16 v[134:135], v49 offset:4608
    v_mfma_f32_16x16x32_bf16 v[208:211], v[92:95], v[64:67], v[208:211]
    ds_read_b64_tr_b16 v[136:137], v9 offset:4096
    s_setprio 0
    s_lshl_b32 s34, s29, 13
    s_lshl_b32 s40, s30, 11
    s_add_u32 s34, s34, s40
    v_mfma_f32_16x16x32_bf16 v[212:215], v[92:95], v[68:71], v[212:215]
    ds_read_b64_tr_b16 v[138:139], v9 offset:4608
    s_lshr_b32 s41, s30, 1
    s_lshl_b32 s41, s41, 15
    s_lshl_b32 s40, s29, 14
    s_add_u32 s41, s41, s40
    v_mfma_f32_16x16x32_bf16 v[216:219], v[92:95], v[72:75], v[216:219]
    ds_read_b64_tr_b16 v[140:141], v50 offset:4096
    s_and_b32 s40, s30, 1
    s_lshl_b32 s40, s40, 13
    s_add_u32 s3, s41, s40
    v_mfma_f32_16x16x32_bf16 v[220:223], v[92:95], v[76:79], v[220:223]
    ds_read_b64_tr_b16 v[142:143], v50 offset:4608
    v_mfma_f32_16x16x32_bf16 v[224:227], v[64:67], v[96:99], v[224:227]
    v_mfma_f32_16x16x32_bf16 v[228:231], v[68:71], v[96:99], v[228:231]
    v_mfma_f32_16x16x32_bf16 v[232:235], v[72:75], v[96:99], v[232:235]
    v_mfma_f32_16x16x32_bf16 v[236:239], v[76:79], v[96:99], v[236:239]
    v_mfma_f32_16x16x32_bf16 v[240:243], v[64:67], v[100:103], v[240:243]
    v_mfma_f32_16x16x32_bf16 v[244:247], v[68:71], v[100:103], v[244:247]
    v_mfma_f32_16x16x32_bf16 v[248:251], v[72:75], v[100:103], v[248:251]
    v_mfma_f32_16x16x32_bf16 v[252:255], v[76:79], v[100:103], v[252:255]
    s_waitcnt lgkmcnt(0)
    s_barrier
    v_mfma_f32_16x16x32_bf16 v[192:195], v[128:131], v[104:107], v[192:195]
    s_setprio 3
    v_mfma_f32_16x16x32_bf16 v[196:199], v[128:131], v[108:111], v[196:199]
    s_lshl_b32 s40, s29, 14
    v_add_u32 v4, s40, v10
    v_mov_b32 v2, v4
    v_add_u32 v3, 32768, v4
    v_add_u32 v5, s45, v10
    v_lshlrev_b32 v149, 2, v0
    v_mfma_f32_16x16x32_bf16 v[200:203], v[128:131], v[112:115], v[200:203]
    v_mfma_f32_16x16x32_bf16 v[204:207], v[128:131], v[116:119], v[204:207]
    v_and_b32 v12, 0x33, v0
    v_bfe_u32 v13, v0, 2, 1
    v_bfe_u32 v14, v0, 3, 1
    v_mfma_f32_16x16x32_bf16 v[208:211], v[132:135], v[104:107], v[208:211]
    v_mfma_f32_16x16x32_bf16 v[212:215], v[132:135], v[108:111], v[212:215]
    v_lshl_add_u32 v12, v13, 3, v12
    v_lshl_add_u32 v12, v14, 2, v12
    v_lshlrev_b32 v7, 4, v12
    v_mfma_f32_16x16x32_bf16 v[216:219], v[132:135], v[112:115], v[216:219]
    v_mfma_f32_16x16x32_bf16 v[220:223], v[132:135], v[116:119], v[220:223]
    v_mfma_f32_16x16x32_bf16 v[224:227], v[104:107], v[136:139], v[224:227]
    v_lshrrev_b32 v12, 3, v0
    v_and_b32 v13, 7, v0
    v_bfe_u32 v14, v12, 1, 1
    v_lshlrev_b32 v14, 2, v14
    v_mfma_f32_16x16x32_bf16 v[228:231], v[108:111], v[136:139], v[228:231]
    v_xor_b32 v13, v13, v14
    s_and_b32 s40, s30, 1
    s_lshl_b32 s40, s40, 1
    v_xor_b32 v13, s40, v13
    s_lshl_b32 s40, s30, 4
    v_add_u32 v12, s40, v12
    v_lshlrev_b32 v6, 11, v12
    v_lshl_add_u32 v6, v13, 4, v6
    v_mfma_f32_16x16x32_bf16 v[232:235], v[112:115], v[136:139], v[232:235]
    v_mov_b32 v64, 0
    v_mov_b32 v65, 0
    v_mov_b32 v66, 0
    v_mov_b32 v67, 0
    v_mfma_f32_16x16x32_bf16 v[236:239], v[116:119], v[136:139], v[236:239]
    v_mov_b32 v68, 0
    v_mov_b32 v69, 0
    v_mov_b32 v70, 0
    v_mov_b32 v71, 0
    v_mfma_f32_16x16x32_bf16 v[240:243], v[104:107], v[140:143], v[240:243]
    s_setprio 2
    v_cvt_pk_bf16_f32 v192, v192, v193
    v_cvt_pk_bf16_f32 v193, v194, v195
    v_cvt_pk_bf16_f32 v194, v196, v197
    v_cvt_pk_bf16_f32 v195, v198, v199
    v_mfma_f32_16x16x32_bf16 v[244:247], v[108:111], v[140:143], v[244:247]
    v_cvt_pk_bf16_f32 v200, v200, v201
    v_cvt_pk_bf16_f32 v201, v202, v203
    v_cvt_pk_bf16_f32 v202, v204, v205
    v_cvt_pk_bf16_f32 v203, v206, v207
    v_mfma_f32_16x16x32_bf16 v[248:251], v[112:115], v[140:143], v[248:251]
    v_cvt_pk_bf16_f32 v208, v208, v209
    v_cvt_pk_bf16_f32 v209, v210, v211
    v_cvt_pk_bf16_f32 v210, v212, v213
    v_cvt_pk_bf16_f32 v211, v214, v215
    v_mfma_f32_16x16x32_bf16 v[252:255], v[116:119], v[140:143], v[252:255]
    v_cvt_pk_bf16_f32 v216, v216, v217
    v_cvt_pk_bf16_f32 v217, v218, v219
    v_cvt_pk_bf16_f32 v218, v220, v221
    v_cvt_pk_bf16_f32 v219, v222, v223
    v_mfma_f32_16x16x32_bf16 v[160:163], v[120:123], v[104:107], v[160:163]
    v_permlane16_swap_b32 v192, v194
    v_permlane16_swap_b32 v193, v195
    v_mfma_f32_16x16x32_bf16 v[164:167], v[120:123], v[108:111], v[164:167]
    v_permlane16_swap_b32 v200, v202
    v_permlane16_swap_b32 v201, v203
    v_mfma_f32_16x16x32_bf16 v[168:171], v[120:123], v[112:115], v[168:171]
    v_permlane16_swap_b32 v208, v210
    v_permlane16_swap_b32 v209, v211
    v_mfma_f32_16x16x32_bf16 v[172:175], v[120:123], v[116:119], v[172:175]
    v_permlane16_swap_b32 v216, v218
    v_permlane16_swap_b32 v217, v219
    v_mfma_f32_16x16x32_bf16 v[176:179], v[124:127], v[104:107], v[176:179]
    v_cvt_pk_bf16_f32 v224, v224, v225
    v_cvt_pk_bf16_f32 v225, v226, v227
    v_cvt_pk_bf16_f32 v226, v240, v241
    v_cvt_pk_bf16_f32 v227, v242, v243
    v_mfma_f32_16x16x32_bf16 v[180:183], v[124:127], v[108:111], v[180:183]
    v_cvt_pk_bf16_f32 v228, v228, v229
    v_cvt_pk_bf16_f32 v229, v230, v231
    v_cvt_pk_bf16_f32 v230, v244, v245
    v_cvt_pk_bf16_f32 v231, v246, v247
    v_mfma_f32_16x16x32_bf16 v[184:187], v[124:127], v[112:115], v[184:187]
    v_cvt_pk_bf16_f32 v232, v232, v233
    v_cvt_pk_bf16_f32 v233, v234, v235
    v_cvt_pk_bf16_f32 v234, v248, v249
    v_cvt_pk_bf16_f32 v235, v250, v251
    v_mfma_f32_16x16x32_bf16 v[188:191], v[124:127], v[116:119], v[188:191]
    v_cvt_pk_bf16_f32 v236, v236, v237
    v_cvt_pk_bf16_f32 v237, v238, v239
    v_cvt_pk_bf16_f32 v238, v252, v253
    v_cvt_pk_bf16_f32 v239, v254, v255
    s_setprio 0
    s_nop 15
    s_nop 1
    v_permlane16_swap_b32 v224, v226
    v_permlane16_swap_b32 v225, v227
    v_permlane16_swap_b32 v228, v230
    v_permlane16_swap_b32 v229, v231
    v_permlane16_swap_b32 v232, v234
    v_permlane16_swap_b32 v233, v235
    v_permlane16_swap_b32 v236, v238
    v_permlane16_swap_b32 v237, v239
    s_cmp_lt_u32 s30, 2
    s_cbranch_scc0 L_late_5
    s_add_u32 s42, s35, 4096
    buffer_store_dwordx4 v[192:195], v7, s[16:19], s35 offen sc1
    buffer_store_dwordx4 v[208:211], v7, s[16:19], s35 offen offset:1024 sc1
    buffer_store_dwordx4 v[224:227], v10, s[16:19], s35 offen offset:2048 sc1
    buffer_store_dwordx4 v[228:231], v10, s[16:19], s35 offen offset:3072 sc1
    buffer_store_dwordx4 v[200:203], v7, s[16:19], s42 offen sc1
    buffer_store_dwordx4 v[216:219], v7, s[16:19], s42 offen offset:1024 sc1
    buffer_store_dwordx4 v[232:235], v10, s[16:19], s42 offen offset:2048 sc1
    buffer_store_dwordx4 v[236:239], v10, s[16:19], s42 offen offset:3072 sc1
L_late_5:
    s_mov_b32 s42, 0x3e8293ee
    s_mov_b32 s43, 0x3e8293ee
    v_pk_mul_f32 v[160:161], v[160:161], s[42:43]
    v_pk_mul_f32 v[162:163], v[162:163], s[42:43]
    v_pk_mul_f32 v[164:165], v[164:165], s[42:43]
    v_pk_mul_f32 v[166:167], v[166:167], s[42:43]
    v_pk_mul_f32 v[168:169], v[168:169], s[42:43]
    v_pk_mul_f32 v[170:171], v[170:171], s[42:43]
    v_pk_mul_f32 v[172:173], v[172:173], s[42:43]
    v_pk_mul_f32 v[174:175], v[174:175], s[42:43]
    v_pk_mul_f32 v[176:177], v[176:177], s[42:43]
    v_pk_mul_f32 v[178:179], v[178:179], s[42:43]
    v_pk_mul_f32 v[180:181], v[180:181], s[42:43]
    v_pk_mul_f32 v[182:183], v[182:183], s[42:43]
    v_pk_mul_f32 v[184:185], v[184:185], s[42:43]
    v_pk_mul_f32 v[186:187], v[186:187], s[42:43]
    v_pk_mul_f32 v[188:189], v[188:189], s[42:43]
    v_pk_mul_f32 v[190:191], v[190:191], s[42:43]
    v_cvt_pk_bf16_f32 v16, v160, v161
    v_cvt_pk_bf16_f32 v17, v162, v163
    v_cvt_pk_bf16_f32 v18, v164, v165
    v_cvt_pk_bf16_f32 v19, v166, v167
    v_cvt_pk_bf16_f32 v20, v176, v177
    v_cvt_pk_bf16_f32 v21, v178, v179
    v_cvt_pk_bf16_f32 v22, v180, v181
    v_cvt_pk_bf16_f32 v23, v182, v183
    v_cvt_pk_bf16_f32 v24, v168, v169
    v_cvt_pk_bf16_f32 v25, v170, v171
    v_cvt_pk_bf16_f32 v26, v172, v173
    v_cvt_pk_bf16_f32 v27, v174, v175
    v_cvt_pk_bf16_f32 v28, v184, v185
    v_cvt_pk_bf16_f32 v29, v186, v187
    v_cvt_pk_bf16_f32 v30, v188, v189
    v_cvt_pk_bf16_f32 v31, v190, v191
    s_nop 1
    v_permlane16_swap_b32 v16, v18
    v_permlane16_swap_b32 v17, v19
    v_permlane16_swap_b32 v20, v22
    v_permlane16_swap_b32 v21, v23
    v_permlane16_swap_b32 v24, v26
    v_permlane16_swap_b32 v25, v27
    v_permlane16_swap_b32 v28, v30
    v_permlane16_swap_b32 v29, v31
    s_nop 1
    v_mfma_f32_32x32x16_bf16 v[104:119], v[192:195], v[16:19], 0
    v_mfma_f32_32x32x16_bf16 v[104:119], v[208:211], v[20:23], v[104:119]
    v_mfma_f32_32x32x16_bf16 v[120:135], v[192:195], v[24:27], 0
    v_mfma_f32_32x32x16_bf16 v[120:135], v[208:211], v[28:31], v[120:135]
    v_add_u32 v12, s3, v10
    v_add_u32 v13, s3, v7
    ds_write_b128 v13, v[192:195] offset:0
    ds_write_b128 v13, v[208:211] offset:1024
    ds_write_b128 v12, v[224:227] offset:2048
    ds_write_b128 v12, v[228:231] offset:3072
    ds_write_b128 v13, v[200:203] offset:4096
    ds_write_b128 v13, v[216:219] offset:5120
    ds_write_b128 v12, v[232:235] offset:6144
    ds_write_b128 v12, v[236:239] offset:7168
    s_nop 7
    v_max3_f32 v12, v104, v105, v106
    v_max3_f32 v12, v12, v107, v108
    v_max3_f32 v12, v12, v109, v110
    v_max3_f32 v12, v12, v111, v112
    v_max3_f32 v12, v12, v113, v114
    v_max3_f32 v12, v12, v115, v116
    v_max3_f32 v12, v12, v117, v118
    v_max_f32 v12, v12, v119
    v_mov_b32 v13, v12
    s_nop 1
    v_permlane32_swap_b32 v13, v12
    s_nop 1
    v_max_f32 v12, v12, v13
    v_sub_f32 v12, 0, v12
    v_mov_b32 v72, v12
    v_mov_b32 v73, v12
    v_mov_b32 v74, v12
    v_mov_b32 v75, v12
    v_mov_b32 v76, v12
    v_mov_b32 v77, v12
    v_mov_b32 v78, v12
    v_mov_b32 v79, v12
    v_mov_b32 v80, v12
    v_mov_b32 v81, v12
    v_mov_b32 v82, v12
    v_mov_b32 v83, v12
    v_mov_b32 v84, v12
    v_mov_b32 v85, v12
    v_mov_b32 v86, v12
    v_mov_b32 v87, v12
    v_max3_f32 v12, v120, v121, v122
    v_max3_f32 v12, v12, v123, v124
    v_max3_f32 v12, v12, v125, v126
    v_max3_f32 v12, v12, v127, v128
    v_max3_f32 v12, v12, v129, v130
    v_max3_f32 v12, v12, v131, v132
    v_max3_f32 v12, v12, v133, v134
    v_max_f32 v12, v12, v135
    v_mov_b32 v13, v12
    s_nop 1
    v_permlane32_swap_b32 v13, v12
    s_nop 1
    v_max_f32 v12, v12, v13
    v_sub_f32 v12, 0, v12
    v_mov_b32 v88, v12
    v_mov_b32 v89, v12
    v_mov_b32 v90, v12
    v_mov_b32 v91, v12
    v_mov_b32 v92, v12
    v_mov_b32 v93, v12
    v_mov_b32 v94, v12
    v_mov_b32 v95, v12
    v_mov_b32 v96, v12
    v_mov_b32 v97, v12
    v_mov_b32 v98, v12
    v_mov_b32 v99, v12
    v_mov_b32 v100, v12
    v_mov_b32 v101, v12
    v_mov_b32 v102, v12
    v_mov_b32 v103, v12
    s_waitcnt lgkmcnt(0)
    s_barrier
    ds_read_b128 v[160:163], v2 offset:0
    ds_read_b128 v[164:167], v2 offset:1024
    ds_read_b128 v[168:171], v2 offset:2048
    s_waitcnt lgkmcnt(1)
    v_mfma_f32_32x32x16_bf16 v[104:119], v[160:163], v[16:19], v[72:87]
    v_mfma_f32_32x32x16_bf16 v[104:119], v[164:167], v[20:23], v[104:119]
    s_waitcnt lgkmcnt(0)
    s_nop 15
    v_mfma_f32_32x32x16_bf16 v[120:135], v[160:163], v[24:27], v[88:103]
    ds_read_b128 v[160:163], v2 offset:4096
    s_setprio 2
    v_exp_f32 v104, v104
    v_exp_f32 v105, v105
    v_exp_f32 v106, v106
    ds_read_b128 v[172:175], v2 offset:3072
    v_exp_f32 v107, v107
    v_exp_f32 v108, v108
    v_exp_f32 v109, v109
    s_waitcnt lgkmcnt(2)
    v_exp_f32 v110, v110
    v_exp_f32 v111, v111
    v_cvt_pk_bf16_f32 v136, v104, v105
    v_cvt_pk_bf16_f32 v137, v106, v107
    v_cvt_pk_bf16_f32 v138, v108, v109
    v_cvt_pk_bf16_f32 v139, v110, v111
    v_mfma_f32_32x32x16_bf16 v[120:135], v[164:167], v[28:31], v[120:135]
    ds_read_b128 v[164:167], v2 offset:5120
    v_exp_f32 v112, v112
    v_exp_f32 v113, v113
    v_exp_f32 v114, v114
    v_mfma_f32_32x32x16_bf16 v[32:47], v[168:171], v[136:139], 0
    s_waitcnt lgkmcnt(2)
    s_mov_b32 s65, s46
    v_exp_f32 v115, v115
    v_exp_f32 v116, v116
    v_exp_f32 v117, v117
    v_exp_f32 v118, v118
    v_exp_f32 v119, v119
    v_cvt_pk_bf16_f32 v140, v112, v113
    v_cvt_pk_bf16_f32 v141, v114, v115
    v_cvt_pk_bf16_f32 v142, v116, v117
    v_cvt_pk_bf16_f32 v143, v118, v119
    v_mfma_f32_32x32x16_bf16 v[104:119], v[160:163], v[16:19], v[72:87]
    s_waitcnt lgkmcnt(1)
    v_exp_f32 v120, v120
    v_exp_f32 v121, v121
    v_exp_f32 v122, v122
    v_mfma_f32_32x32x16_bf16 v[32:47], v[172:175], v[140:143], v[32:47]
    s_add_u32 s39, s39, 16384
    v_exp_f32 v123, v123
    v_exp_f32 v124, v124
    v_exp_f32 v125, v125
    v_smfmac_f32_16x16x64_bf16 v[64:67], v[144:147], v[136:143], v148
    s_waitcnt lgkmcnt(0)
    v_exp_f32 v126, v126
    v_exp_f32 v127, v127
    v_cvt_pk_bf16_f32 v136, v120, v121
    v_cvt_pk_bf16_f32 v137, v122, v123
    v_cvt_pk_bf16_f32 v138, v124, v125
    v_cvt_pk_bf16_f32 v139, v126, v127
    v_mfma_f32_32x32x16_bf16 v[104:119], v[164:167], v[20:23], v[104:119]
    s_and_b32 s39, s39, 0x3ffff
    v_exp_f32 v128, v128
    v_exp_f32 v129, v129
    v_exp_f32 v130, v130
    v_mfma_f32_32x32x16_bf16 v[48:63], v[168:171], v[136:139], 0
    ds_read_b128 v[168:171], v2 offset:6144
    v_exp_f32 v131, v131
    v_exp_f32 v132, v132
    v_exp_f32 v133, v133
    v_exp_f32 v134, v134
    v_exp_f32 v135, v135
    v_cvt_pk_bf16_f32 v140, v128, v129
    v_cvt_pk_bf16_f32 v141, v130, v131
    v_cvt_pk_bf16_f32 v142, v132, v133
    v_cvt_pk_bf16_f32 v143, v134, v135
    v_mfma_f32_32x32x16_bf16 v[120:135], v[160:163], v[24:27], v[88:103]
    ds_read_b128 v[160:163], v2 offset:8192
    s_setprio 1
    v_exp_f32 v104, v104
    v_exp_f32 v105, v105
    v_exp_f32 v106, v106
    v_mfma_f32_32x32x16_bf16 v[48:63], v[172:175], v[140:143], v[48:63]
    ds_read_b128 v[172:175], v2 offset:7168
    v_exp_f32 v107, v107
    v_exp_f32 v108, v108
    v_exp_f32 v109, v109
    v_smfmac_f32_16x16x64_bf16 v[68:71], v[144:147], v[136:143], v148
    s_waitcnt lgkmcnt(2)
    v_exp_f32 v110, v110
    v_exp_f32 v111, v111
    v_cvt_pk_bf16_f32 v136, v104, v105
    v_cvt_pk_bf16_f32 v137, v106, v107
    v_cvt_pk_bf16_f32 v138, v108, v109
    v_cvt_pk_bf16_f32 v139, v110, v111
    v_mfma_f32_32x32x16_bf16 v[120:135], v[164:167], v[28:31], v[120:135]
    ds_read_b128 v[164:167], v2 offset:9216
    v_exp_f32 v112, v112
    v_exp_f32 v113, v113
    v_exp_f32 v114, v114
    v_mfma_f32_32x32x16_bf16 v[32:47], v[168:171], v[136:139], v[32:47]
    s_waitcnt lgkmcnt(2)
    v_exp_f32 v115, v115
    v_exp_f32 v116, v116
    v_exp_f32 v117, v117
    v_exp_f32 v118, v118
    v_exp_f32 v119, v119
    v_cvt_pk_bf16_f32 v140, v112, v113
    v_cvt_pk_bf16_f32 v141, v114, v115
    v_cvt_pk_bf16_f32 v142, v116, v117
    v_cvt_pk_bf16_f32 v143, v118, v119
    v_mfma_f32_32x32x16_bf16 v[104:119], v[160:163], v[16:19], v[72:87]
    s_waitcnt lgkmcnt(1)
    v_exp_f32 v120, v120
    v_exp_f32 v121, v121
    v_exp_f32 v122, v122
    v_mfma_f32_32x32x16_bf16 v[32:47], v[172:175], v[140:143], v[32:47]
    s_add_u32 s46, s46, 32768
    v_exp_f32 v123, v123
    v_exp_f32 v124, v124
    v_exp_f32 v125, v125
    v_smfmac_f32_16x16x64_bf16 v[64:67], v[144:147], v[136:143], v148
    s_waitcnt lgkmcnt(0)
    v_exp_f32 v126, v126
    v_exp_f32 v127, v127
    v_cvt_pk_bf16_f32 v136, v120, v121
    v_cvt_pk_bf16_f32 v137, v122, v123
    v_cvt_pk_bf16_f32 v138, v124, v125
    v_cvt_pk_bf16_f32 v139, v126, v127
    v_mfma_f32_32x32x16_bf16 v[104:119], v[164:167], v[20:23], v[104:119]
    s_and_b32 s46, s46, 0x1ffff
    v_exp_f32 v128, v128
    v_exp_f32 v129, v129
    v_exp_f32 v130, v130
    v_mfma_f32_32x32x16_bf16 v[48:63], v[168:171], v[136:139], v[48:63]
    ds_read_b128 v[168:171], v2 offset:10240
    s_waitcnt vmcnt(0)
    s_barrier
    v_exp_f32 v131, v131
    v_exp_f32 v132, v132
    v_exp_f32 v133, v133
    v_exp_f32 v134, v134
    v_exp_f32 v135, v135
    v_cvt_pk_bf16_f32 v140, v128, v129
    v_cvt_pk_bf16_f32 v141, v130, v131
    v_cvt_pk_bf16_f32 v142, v132, v133
    v_cvt_pk_bf16_f32 v143, v134, v135
    s_cmp_ge_u32 s30, 2
    s_cbranch_scc0 L_ns_6
    s_add_u32 s42, s35, 4096
    buffer_store_dwordx4 v[192:195], v7, s[16:19], s35 offen sc1
    buffer_store_dwordx4 v[208:211], v7, s[16:19], s35 offen offset:1024 sc1
    buffer_store_dwordx4 v[224:227], v10, s[16:19], s35 offen offset:2048 sc1
    buffer_store_dwordx4 v[228:231], v10, s[16:19], s35 offen offset:3072 sc1
    buffer_store_dwordx4 v[200:203], v7, s[16:19], s42 offen sc1
    buffer_store_dwordx4 v[216:219], v7, s[16:19], s42 offen offset:1024 sc1
    buffer_store_dwordx4 v[232:235], v10, s[16:19], s42 offen offset:2048 sc1
    buffer_store_dwordx4 v[236:239], v10, s[16:19], s42 offen offset:3072 sc1
L_ns_6:
    s_cmp_eq_u32 s28, 0
    s_cbranch_scc0 L_np_7
    s_mov_b32 s41, 400000
    s_mov_b32 s42, 0x55555555
    v_lshlrev_b32 v12, 2, v0
L_rdy_8:
    v_cmp_eq_u32 vcc, 8, v15
    s_nop 3
    s_and_b32 s40, vcc_lo, s42
    s_and_b32 s43, vcc_hi, s42
    s_and_b32 s40, s40, s43
    s_cmp_eq_u32 s40, s42
    s_cbranch_scc1 L_rdyok_9
    s_sub_u32 s41, s41, 1
    s_cbranch_scc1 L_rdyok_9
    buffer_load_dword v15, v12, s[20:23], 0 offen sc1
    s_waitcnt vmcnt(0)
    s_branch L_rdy_8
L_rdyok_9:
    s_lshl_b32 s40, s31, 10
    s_lshl_b32 s41, s32, 2
    s_add_u32 s40, s40, s41
    s_add_u32 s40, s40, 26214400
    v_lshlrev_b32 v12, 7, v0
    v_mov_b32 v13, 1
    s_mov_b64 exec, 0xff
    buffer_store_dword v13, v12, s[16:19], s40 offen sc1
    s_mov_b64 exec, -1
L_np_7:
    v_mfma_f32_32x32x16_bf16 v[120:135], v[160:163], v[24:27], v[88:103]
    ds_read_b128 v[160:163], v2 offset:12288
    s_setprio 0
    v_exp_f32 v104, v104
    v_exp_f32 v105, v105
    v_exp_f32 v106, v106
    v_mfma_f32_32x32x16_bf16 v[48:63], v[172:175], v[140:143], v[48:63]
    ds_read_b128 v[172:175], v2 offset:11264
    v_exp_f32 v107, v107
    v_exp_f32 v108, v108
    v_exp_f32 v109, v109
    v_smfmac_f32_16x16x64_bf16 v[68:71], v[144:147], v[136:143], v148
    s_waitcnt lgkmcnt(2)
    v_exp_f32 v110, v110
    v_exp_f32 v111, v111
    v_cvt_pk_bf16_f32 v136, v104, v105
    v_cvt_pk_bf16_f32 v137, v106, v107
    v_cvt_pk_bf16_f32 v138, v108, v109
    v_cvt_pk_bf16_f32 v139, v110, v111
    v_mfma_f32_32x32x16_bf16 v[120:135], v[164:167], v[28:31], v[120:135]
    ds_read_b128 v[164:167], v2 offset:13312
    v_exp_f32 v112, v112
    v_exp_f32 v113, v113
    v_exp_f32 v114, v114
    v_mfma_f32_32x32x16_bf16 v[32:47], v[168:171], v[136:139], v[32:47]
    s_waitcnt lgkmcnt(2)
    v_exp_f32 v115, v115
    v_exp_f32 v116, v116
    v_exp_f32 v117, v117
    v_exp_f32 v118, v118
    v_exp_f32 v119, v119
    v_cvt_pk_bf16_f32 v140, v112, v113
    v_cvt_pk_bf16_f32 v141, v114, v115
    v_cvt_pk_bf16_f32 v142, v116, v117
    v_cvt_pk_bf16_f32 v143, v118, v119
    v_mfma_f32_32x32x16_bf16 v[104:119], v[160:163], v[16:19], v[72:87]
    s_waitcnt lgkmcnt(1)
    v_exp_f32 v120, v120
    v_exp_f32 v121, v121
    v_exp_f32 v122, v122
    v_mfma_f32_32x32x16_bf16 v[32:47], v[172:175], v[140:143], v[32:47]
    s_add_u32 m0, s46, s55
    v_exp_f32 v123, v123
    v_exp_f32 v124, v124
    v_exp_f32 v125, v125
    v_smfmac_f32_16x16x64_bf16 v[64:67], v[144:147], v[136:143], v148
    s_waitcnt lgkmcnt(0)
    v_exp_f32 v126, v126
    v_exp_f32 v127, v127
    v_cvt_pk_bf16_f32 v136, v120, v121
    v_cvt_pk_bf16_f32 v137, v122, v123
    v_cvt_pk_bf16_f32 v138, v124, v125
    v_cvt_pk_bf16_f32 v139, v126, v127
    v_mfma_f32_32x32x16_bf16 v[104:119], v[164:167], v[20:23], v[104:119]
    s_add_u32 s38, s38, 1
    v_exp_f32 v128, v128
    v_exp_f32 v129, v129
    v_exp_f32 v130, v130
    v_mfma_f32_32x32x16_bf16 v[48:63], v[168:171], v[136:139], v[48:63]
    ds_read_b128 v[168:171], v2 offset:14336
    s_barrier
    s_setprio 3
    v_exp_f32 v131, v131
    v_exp_f32 v132, v132
    v_exp_f32 v133, v133
    v_exp_f32 v134, v134
    v_exp_f32 v135, v135
    v_cvt_pk_bf16_f32 v140, v128, v129
    v_cvt_pk_bf16_f32 v141, v130, v131
    v_cvt_pk_bf16_f32 v142, v132, v133
    v_cvt_pk_bf16_f32 v143, v134, v135
    v_mfma_f32_32x32x16_bf16 v[120:135], v[160:163], v[24:27], v[88:103]
    ds_read_b128 v[160:163], v3 offset:0
    v_exp_f32 v104, v104
    v_exp_f32 v105, v105
    v_exp_f32 v106, v106
    v_mfma_f32_32x32x16_bf16 v[48:63], v[172:175], v[140:143], v[48:63]
    ds_read_b128 v[172:175], v2 offset:15360
    v_exp_f32 v107, v107
    v_exp_f32 v108, v108
    v_exp_f32 v109, v109
    v_smfmac_f32_16x16x64_bf16 v[68:71], v[144:147], v[136:143], v148
    s_waitcnt lgkmcnt(2)
    v_exp_f32 v110, v110
    v_exp_f32 v111, v111
    v_cvt_pk_bf16_f32 v136, v104, v105
    v_cvt_pk_bf16_f32 v137, v106, v107
    v_cvt_pk_bf16_f32 v138, v108, v109
    v_cvt_pk_bf16_f32 v139, v110, v111
    v_mfma_f32_32x32x16_bf16 v[120:135], v[164:167], v[28:31], v[120:135]
    ds_read_b128 v[164:167], v3 offset:1024
    v_exp_f32 v112, v112
    v_exp_f32 v113, v113
    v_exp_f32 v114, v114
    v_mfma_f32_32x32x16_bf16 v[32:47], v[168:171], v[136:139], v[32:47]
    s_waitcnt lgkmcnt(2)
    v_exp_f32 v115, v115
    v_exp_f32 v116, v116
    v_exp_f32 v117, v117
    v_exp_f32 v118, v118
    v_exp_f32 v119, v119
    v_cvt_pk_bf16_f32 v140, v112, v113
    v_cvt_pk_bf16_f32 v141, v114, v115
    v_cvt_pk_bf16_f32 v142, v116, v117
    v_cvt_pk_bf16_f32 v143, v118, v119
    v_mfma_f32_32x32x16_bf16 v[104:119], v[160:163], v[16:19], v[72:87]
    s_waitcnt lgkmcnt(1)
    v_exp_f32 v120, v120
    v_exp_f32 v121, v121
    v_exp_f32 v122, v122
    v_mfma_f32_32x32x16_bf16 v[32:47], v[172:175], v[140:143], v[32:47]
    v_exp_f32 v123, v123
    v_exp_f32 v124, v124
    v_exp_f32 v125, v125
    v_smfmac_f32_16x16x64_bf16 v[64:67], v[144:147], v[136:143], v148
    s_waitcnt lgkmcnt(0)
    v_exp_f32 v126, v126
    v_exp_f32 v127, v127
    v_cvt_pk_bf16_f32 v136, v120, v121
    v_cvt_pk_bf16_f32 v137, v122, v123
    v_cvt_pk_bf16_f32 v138, v124, v125
    v_cvt_pk_bf16_f32 v139, v126, v127
    v_mfma_f32_32x32x16_bf16 v[104:119], v[164:167], v[20:23], v[104:119]
    v_exp_f32 v128, v128
    v_exp_f32 v129, v129
    v_exp_f32 v130, v130
    v_mfma_f32_32x32x16_bf16 v[48:63], v[168:171], v[136:139], v[48:63]
    ds_read_b128 v[168:171], v3 offset:2048
    v_exp_f32 v131, v131
    v_exp_f32 v132, v132
    v_exp_f32 v133, v133
    v_exp_f32 v134, v134
    v_exp_f32 v135, v135
    v_cvt_pk_bf16_f32 v140, v128, v129
    v_cvt_pk_bf16_f32 v141, v130, v131
    v_cvt_pk_bf16_f32 v142, v132, v133
    v_cvt_pk_bf16_f32 v143, v134, v135
    v_mov_b32 v2, v3
    v_add_u32 v3, s65, v4
    s_cmp_eq_u32 s28, 0
    s_cbranch_scc0 L_smp_10
    s_mov_b32 exec_lo, 0xffff
    s_mov_b32 exec_hi, 0
    buffer_load_dword v150, v149, s[16:19], s54 offen sc1
    s_mov_b64 exec, -1
    s_nop 3
L_smp_10:
    v_mfma_f32_32x32x16_bf16 v[120:135], v[160:163], v[24:27], v[88:103]
    ds_read_b128 v[160:163], v2 offset:4096
    s_setprio 2
    v_exp_f32 v104, v104
    v_exp_f32 v105, v105
    v_exp_f32 v106, v106
    v_mfma_f32_32x32x16_bf16 v[48:63], v[172:175], v[140:143], v[48:63]
    ds_read_b128 v[172:175], v2 offset:3072
    v_exp_f32 v107, v107
    v_exp_f32 v108, v108
    v_exp_f32 v109, v109
    v_smfmac_f32_16x16x64_bf16 v[68:71], v[144:147], v[136:143], v148
    s_waitcnt lgkmcnt(2)
    v_exp_f32 v110, v110
    v_exp_f32 v111, v111
    v_cvt_pk_bf16_f32 v136, v104, v105
    v_cvt_pk_bf16_f32 v137, v106, v107
    v_cvt_pk_bf16_f32 v138, v108, v109
    v_cvt_pk_bf16_f32 v139, v110, v111
    v_mfma_f32_32x32x16_bf16 v[120:135], v[164:167], v[28:31], v[120:135]
    ds_read_b128 v[164:167], v2 offset:5120
    v_exp_f32 v112, v112
    v_exp_f32 v113, v113
    v_exp_f32 v114, v114
    v_mfma_f32_32x32x16_bf16 v[32:47], v[168:171], v[136:139], v[32:47]
    s_waitcnt lgkmcnt(2)
    s_mov_b32 s65, s46
    v_exp_f32 v115, v115
    v_exp_f32 v116, v116
    v_exp_f32 v117, v117
    v_exp_f32 v118, v118
    v_exp_f32 v119, v119
    v_cvt_pk_bf16_f32 v140, v112, v113
    v_cvt_pk_bf16_f32 v141, v114, v115
    v_cvt_pk_bf16_f32 v142, v116, v117
    v_cvt_pk_bf16_f32 v143, v118, v119
    v_mfma_f32_32x32x16_bf16 v[104:119], v[160:163], v[16:19], v[72:87]
    s_waitcnt lgkmcnt(1)
    v_exp_f32 v120, v120
    v_exp_f32 v121, v121
    v_exp_f32 v122, v122
    v_mfma_f32_32x32x16_bf16 v[32:47], v[172:175], v[140:143], v[32:47]
    s_add_u32 s39, s39, 16384
    v_exp_f32 v123, v123
    v_exp_f32 v124, v124
    v_exp_f32 v125, v125
    v_smfmac_f32_16x16x64_bf16 v[64:67], v[144:147], v[136:143], v148
    s_waitcnt lgkmcnt(0)
    v_exp_f32 v126, v126
    v_exp_f32 v127, v127
    v_cvt_pk_bf16_f32 v136, v120, v121
    v_cvt_pk_bf16_f32 v137, v122, v123
    v_cvt_pk_bf16_f32 v138, v124, v125
    v_cvt_pk_bf16_f32 v139, v126, v127
    v_mfma_f32_32x32x16_bf16 v[104:119], v[164:167], v[20:23], v[104:119]
    s_and_b32 s39, s39, 0x3ffff
    v_exp_f32 v128, v128
    v_exp_f32 v129, v129
    v_exp_f32 v130, v130
    v_mfma_f32_32x32x16_bf16 v[48:63], v[168:171], v[136:139], v[48:63]
    ds_read_b128 v[168:171], v2 offset:6144
    v_exp_f32 v131, v131
    v_exp_f32 v132, v132
    v_exp_f32 v133, v133
    v_exp_f32 v134, v134
    v_exp_f32 v135, v135
    v_cvt_pk_bf16_f32 v140, v128, v129
    v_cvt_pk_bf16_f32 v141, v130, v131
    v_cvt_pk_bf16_f32 v142, v132, v133
    v_cvt_pk_bf16_f32 v143, v134, v135
    s_waitcnt vmcnt(0)
    s_cmp_eq_u32 s28, 0
    s_cbranch_scc0 L_go_11
    s_mov_b32 s41, 400000
    s_add_u32 s42, s32, 1
    s_and_b32 s42, s42, 7
    s_lshl_b32 s42, 1, s42
    s_mov_b64 exec, 0xffff
L_poll_12:
    s_waitcnt vmcnt(0)
    v_cmp_eq_u32 vcc, 1, v150
    s_nop 3
    s_and_b32 s43, vcc_lo, s42
    s_cmp_eq_u32 s43, s42
    s_cbranch_scc1 L_pdone_13
    s_sub_u32 s41, s41, 1
    s_cbranch_scc1 L_pdone_13
    buffer_load_dword v150, v149, s[16:19], s54 offen sc1
    s_branch L_poll_12
L_pdone_13:
    s_mov_b64 exec, -1
L_go_11:
    s_barrier
    s_lshl_b32 s40, s32, 1
    s_add_u32 s40, s40, 2
    s_and_b32 s40, s40, 15
    s_lshl_b32 s64, s40, 14
    s_add_u32 m0, s55, 65536
    s_nop 0
    buffer_load_dwordx4 v5, s[16:19], s64 offen offset:0 sc1 lds
    buffer_load_dwordx4 v5, s[16:19], s64 offen offset:1024 sc1 lds
    buffer_load_dwordx4 v5, s[16:19], s64 offen offset:2048 sc1 lds
    buffer_load_dwordx4 v5, s[16:19], s64 offen offset:3072 sc1 lds
    s_cmp_eq_u32 s28, 0
    s_cbranch_scc0 L_nb_14
    s_lshl_b32 s40, s31, 10
    s_lshl_b32 s41, s32, 2
    s_add_u32 s40, s40, s41
    s_add_u32 s40, s40, 26214432
    v_lshlrev_b32 v12, 7, v0
    v_mov_b32 v13, 1
    s_mov_b64 exec, 0xff
    buffer_store_dword v13, v12, s[16:19], s40 offen sc1
    s_mov_b64 exec, -1
L_nb_14:
    v_mfma_f32_32x32x16_bf16 v[120:135], v[160:163], v[24:27], v[88:103]
    ds_read_b128 v[160:163], v2 offset:8192
    s_setprio 1
    v_exp_f32 v104, v104
    v_exp_f32 v105, v105
    v_exp_f32 v106, v106
    v_mfma_f32_32x32x16_bf16 v[48:63], v[172:175], v[140:143], v[48:63]
    ds_read_b128 v[172:175], v2 offset:7168
    v_exp_f32 v107, v107
    v_exp_f32 v108, v108
    v_exp_f32 v109, v109
    v_smfmac_f32_16x16x64_bf16 v[68:71], v[144:147], v[136:143], v148
    s_waitcnt lgkmcnt(2)
    v_exp_f32 v110, v110
    v_exp_f32 v111, v111
    v_cvt_pk_bf16_f32 v136, v104, v105
    v_cvt_pk_bf16_f32 v137, v106, v107
    v_cvt_pk_bf16_f32 v138, v108, v109
    v_cvt_pk_bf16_f32 v139, v110, v111
    v_mfma_f32_32x32x16_bf16 v[120:135], v[164:167], v[28:31], v[120:135]
    ds_read_b128 v[164:167], v2 offset:9216
    v_exp_f32 v112, v112
    v_exp_f32 v113, v113
    v_exp_f32 v114, v114
    v_mfma_f32_32x32x16_bf16 v[32:47], v[168:171], v[136:139], v[32:47]
    s_waitcnt lgkmcnt(2)
    v_exp_f32 v115, v115
    v_exp_f32 v116, v116
    v_exp_f32 v117, v117
    v_exp_f32 v118, v118
    v_exp_f32 v119, v119
    v_cvt_pk_bf16_f32 v140, v112, v113
    v_cvt_pk_bf16_f32 v141, v114, v115
    v_cvt_pk_bf16_f32 v142, v116, v117
    v_cvt_pk_bf16_f32 v143, v118, v119
    v_mfma_f32_32x32x16_bf16 v[104:119], v[160:163], v[16:19], v[72:87]
    s_waitcnt lgkmcnt(1)
    v_exp_f32 v120, v120
    v_exp_f32 v121, v121
    v_exp_f32 v122, v122
    v_mfma_f32_32x32x16_bf16 v[32:47], v[172:175], v[140:143], v[32:47]
    s_add_u32 s46, s46, 32768
    v_exp_f32 v123, v123
    v_exp_f32 v124, v124
    v_exp_f32 v125, v125
    v_smfmac_f32_16x16x64_bf16 v[64:67], v[144:147], v[136:143], v148
    s_waitcnt lgkmcnt(0)
    v_exp_f32 v126, v126
    v_exp_f32 v127, v127
    v_cvt_pk_bf16_f32 v136, v120, v121
    v_cvt_pk_bf16_f32 v137, v122, v123
    v_cvt_pk_bf16_f32 v138, v124, v125
    v_cvt_pk_bf16_f32 v139, v126, v127
    v_mfma_f32_32x32x16_bf16 v[104:119], v[164:167], v[20:23], v[104:119]
    s_and_b32 s46, s46, 0x1ffff
    v_exp_f32 v128, v128
    v_exp_f32 v129, v129
    v_exp_f32 v130, v130
    v_mfma_f32_32x32x16_bf16 v[48:63], v[168:171], v[136:139], v[48:63]
    ds_read_b128 v[168:171], v2 offset:10240
    v_exp_f32 v131, v131
    v_exp_f32 v132, v132
    v_exp_f32 v133, v133
    v_exp_f32 v134, v134
    v_exp_f32 v135, v135
    v_cvt_pk_bf16_f32 v140, v128, v129
    v_cvt_pk_bf16_f32 v141, v130, v131
    v_cvt_pk_bf16_f32 v142, v132, v133
    v_cvt_pk_bf16_f32 v143, v134, v135
    s_cmp_eq_u32 s28, 0
    s_cbranch_scc0 L_smp_15
    s_mov_b32 exec_lo, 0xffff
    s_mov_b32 exec_hi, 0
    buffer_load_dword v150, v149, s[16:19], s54 offen sc1
    s_mov_b64 exec, -1
    s_nop 3
L_smp_15:
    v_mfma_f32_32x32x16_bf16 v[120:135], v[160:163], v[24:27], v[88:103]
    ds_read_b128 v[160:163], v2 offset:12288
    s_setprio 0
    v_exp_f32 v104, v104
    v_exp_f32 v105, v105
    v_exp_f32 v106, v106
    v_mfma_f32_32x32x16_bf16 v[48:63], v[172:175], v[140:143], v[48:63]
    ds_read_b128 v[172:175], v2 offset:11264
    v_exp_f32 v107, v107
    v_exp_f32 v108, v108
    v_exp_f32 v109, v109
    v_smfmac_f32_16x16x64_bf16 v[68:71], v[144:147], v[136:143], v148
    s_waitcnt lgkmcnt(2)
    v_exp_f32 v110, v110
    v_exp_f32 v111, v111
    v_cvt_pk_bf16_f32 v136, v104, v105
    v_cvt_pk_bf16_f32 v137, v106, v107
    v_cvt_pk_bf16_f32 v138, v108, v109
    v_cvt_pk_bf16_f32 v139, v110, v111
    v_mfma_f32_32x32x16_bf16 v[120:135], v[164:167], v[28:31], v[120:135]
    ds_read_b128 v[164:167], v2 offset:13312
    v_exp_f32 v112, v112
    v_exp_f32 v113, v113
    v_exp_f32 v114, v114
    v_mfma_f32_32x32x16_bf16 v[32:47], v[168:171], v[136:139], v[32:47]
    s_waitcnt lgkmcnt(2)
    v_exp_f32 v115, v115
    v_exp_f32 v116, v116
    v_exp_f32 v117, v117
    v_exp_f32 v118, v118
    v_exp_f32 v119, v119
    v_cvt_pk_bf16_f32 v140, v112, v113
    v_cvt_pk_bf16_f32 v141, v114, v115
    v_cvt_pk_bf16_f32 v142, v116, v117
    v_cvt_pk_bf16_f32 v143, v118, v119
    v_mfma_f32_32x32x16_bf16 v[104:119], v[160:163], v[16:19], v[72:87]
    s_waitcnt lgkmcnt(1)
    v_exp_f32 v120, v120
    v_exp_f32 v121, v121
    v_exp_f32 v122, v122
    v_mfma_f32_32x32x16_bf16 v[32:47], v[172:175], v[140:143], v[32:47]
    s_add_u32 m0, s46, s55
    v_exp_f32 v123, v123
    v_exp_f32 v124, v124
    v_exp_f32 v125, v125
    v_smfmac_f32_16x16x64_bf16 v[64:67], v[144:147], v[136:143], v148
    s_waitcnt lgkmcnt(0)
    v_exp_f32 v126, v126
    v_exp_f32 v127, v127
    v_cvt_pk_bf16_f32 v136, v120, v121
    v_cvt_pk_bf16_f32 v137, v122, v123
    v_cvt_pk_bf16_f32 v138, v124, v125
    v_cvt_pk_bf16_f32 v139, v126, v127
    v_mfma_f32_32x32x16_bf16 v[104:119], v[164:167], v[20:23], v[104:119]
    s_add_u32 s38, s38, 1
    v_exp_f32 v128, v128
    v_exp_f32 v129, v129
    v_exp_f32 v130, v130
    v_mfma_f32_32x32x16_bf16 v[48:63], v[168:171], v[136:139], v[48:63]
    ds_read_b128 v[168:171], v2 offset:14336
    v_exp_f32 v131, v131
    v_exp_f32 v132, v132
    v_exp_f32 v133, v133
    v_exp_f32 v134, v134
    v_exp_f32 v135, v135
    v_cvt_pk_bf16_f32 v140, v128, v129
    v_cvt_pk_bf16_f32 v141, v130, v131
    v_cvt_pk_bf16_f32 v142, v132, v133
    v_cvt_pk_bf16_f32 v143, v134, v135
    s_cmp_eq_u32 s28, 0
    s_cbranch_scc0 L_go_16
    s_mov_b32 s41, 400000
    s_add_u32 s42, s32, 1
    s_and_b32 s42, s42, 7
    s_lshl_b32 s42, 1, s42
    s_lshl_b32 s42, s42, 8
    s_add_u32 s43, s32, 2
    s_and_b32 s43, s43, 7
    s_lshl_b32 s43, 1, s43
    s_or_b32 s42, s42, s43
    s_mov_b64 exec, 0xffff
L_poll_17:
    s_waitcnt vmcnt(0)
    v_cmp_eq_u32 vcc, 1, v150
    s_nop 3
    s_and_b32 s43, vcc_lo, s42
    s_cmp_eq_u32 s43, s42
    s_cbranch_scc1 L_pdone_18
    s_sub_u32 s41, s41, 1
    s_cbranch_scc1 L_pdone_18
    buffer_load_dword v150, v149, s[16:19], s54 offen sc1
    s_branch L_poll_17
L_pdone_18:
    s_mov_b64 exec, -1
L_go_16:
    s_waitcnt vmcnt(0)
    s_barrier
    s_lshl_b32 s40, s32, 1
    s_add_u32 s40, s40, 3
    s_and_b32 s40, s40, 15
    s_lshl_b32 s64, s40, 14
    s_add_u32 m0, s55, 98304
    s_nop 0
    buffer_load_dwordx4 v5, s[16:19], s64 offen offset:0 sc1 lds
    buffer_load_dwordx4 v5, s[16:19], s64 offen offset:1024 sc1 lds
    buffer_load_dwordx4 v5, s[16:19], s64 offen offset:2048 sc1 lds
    buffer_load_dwordx4 v5, s[16:19], s64 offen offset:3072 sc1 lds
    s_add_u32 m0, s46, s55
    s_setprio 3
    v_mfma_f32_32x32x16_bf16 v[120:135], v[160:163], v[24:27], v[88:103]
    ds_read_b128 v[160:163], v3 offset:0
    v_exp_f32 v104, v104
    v_exp_f32 v105, v105
    v_exp_f32 v106, v106
    v_mfma_f32_32x32x16_bf16 v[48:63], v[172:175], v[140:143], v[48:63]
    ds_read_b128 v[172:175], v2 offset:15360
    v_exp_f32 v107, v107
    v_exp_f32 v108, v108
    v_exp_f32 v109, v109
    v_smfmac_f32_16x16x64_bf16 v[68:71], v[144:147], v[136:143], v148
    s_waitcnt lgkmcnt(2)
    buffer_load_dwordx4 v5, s[16:19], s39 offen offset:0 sc1 lds
    v_exp_f32 v110, v110
    v_exp_f32 v111, v111
    v_cvt_pk_bf16_f32 v136, v104, v105
    v_cvt_pk_bf16_f32 v137, v106, v107
    v_cvt_pk_bf16_f32 v138, v108, v109
    v_cvt_pk_bf16_f32 v139, v110, v111
    v_mfma_f32_32x32x16_bf16 v[120:135], v[164:167], v[28:31], v[120:135]
    ds_read_b128 v[164:167], v3 offset:1024
    v_exp_f32 v112, v112
    v_exp_f32 v113, v113
    v_exp_f32 v114, v114
    v_mfma_f32_32x32x16_bf16 v[32:47], v[168:171], v[136:139], v[32:47]
    s_waitcnt lgkmcnt(2)
    buffer_load_dwordx4 v5, s[16:19], s39 offen offset:1024 sc1 lds
    v_exp_f32 v115, v115
    v_exp_f32 v116, v116
    v_exp_f32 v117, v117
    v_exp_f32 v118, v118
    v_exp_f32 v119, v119
    v_cvt_pk_bf16_f32 v140, v112, v113
    v_cvt_pk_bf16_f32 v141, v114, v115
    v_cvt_pk_bf16_f32 v142, v116, v117
    v_cvt_pk_bf16_f32 v143, v118, v119
    v_mfma_f32_32x32x16_bf16 v[104:119], v[160:163], v[16:19], v[72:87]
    s_waitcnt lgkmcnt(1)
    v_exp_f32 v120, v120
    v_exp_f32 v121, v121
    v_exp_f32 v122, v122
    v_mfma_f32_32x32x16_bf16 v[32:47], v[172:175], v[140:143], v[32:47]
    buffer_load_dwordx4 v5, s[16:19], s39 offen offset:2048 sc1 lds
    v_exp_f32 v123, v123
    v_exp_f32 v124, v124
    v_exp_f32 v125, v125
    v_smfmac_f32_16x16x64_bf16 v[64:67], v[144:147], v[136:143], v148
    s_waitcnt lgkmcnt(0)
    v_exp_f32 v126, v126
    v_exp_f32 v127, v127
    v_cvt_pk_bf16_f32 v136, v120, v121
    v_cvt_pk_bf16_f32 v137, v122, v123
    v_cvt_pk_bf16_f32 v138, v124, v125
    v_cvt_pk_bf16_f32 v139, v126, v127
    v_mfma_f32_32x32x16_bf16 v[104:119], v[164:167], v[20:23], v[104:119]
    buffer_load_dwordx4 v5, s[16:19], s39 offen offset:3072 sc1 lds
    v_exp_f32 v128, v128
    v_exp_f32 v129, v129
    v_exp_f32 v130, v130
    v_mfma_f32_32x32x16_bf16 v[48:63], v[168:171], v[136:139], v[48:63]
    ds_read_b128 v[168:171], v3 offset:2048
    v_exp_f32 v131, v131
    v_exp_f32 v132, v132
    v_exp_f32 v133, v133
    v_exp_f32 v134, v134
    v_exp_f32 v135, v135
    v_cvt_pk_bf16_f32 v140, v128, v129
    v_cvt_pk_bf16_f32 v141, v130, v131
    v_cvt_pk_bf16_f32 v142, v132, v133
    v_cvt_pk_bf16_f32 v143, v134, v135
    v_mov_b32 v2, v3
    v_add_u32 v3, s65, v4
    v_mfma_f32_32x32x16_bf16 v[120:135], v[160:163], v[24:27], v[88:103]
    ds_read_b128 v[160:163], v2 offset:4096
    s_setprio 2
    v_exp_f32 v104, v104
    v_exp_f32 v105, v105
    v_exp_f32 v106, v106
    v_mfma_f32_32x32x16_bf16 v[48:63], v[172:175], v[140:143], v[48:63]
    ds_read_b128 v[172:175], v2 offset:3072
    v_exp_f32 v107, v107
    v_exp_f32 v108, v108
    v_exp_f32 v109, v109
    v_smfmac_f32_16x16x64_bf16 v[68:71], v[144:147], v[136:143], v148
    s_waitcnt lgkmcnt(2)
    v_exp_f32 v110, v110
    v_exp_f32 v111, v111
    v_cvt_pk_bf16_f32 v136, v104, v105
    v_cvt_pk_bf16_f32 v137, v106, v107
    v_cvt_pk_bf16_f32 v138, v108, v109
    v_cvt_pk_bf16_f32 v139, v110, v111
    v_mfma_f32_32x32x16_bf16 v[120:135], v[164:167], v[28:31], v[120:135]
    ds_read_b128 v[164:167], v2 offset:5120
    v_exp_f32 v112, v112
    v_exp_f32 v113, v113
    v_exp_f32 v114, v114
    v_mfma_f32_32x32x16_bf16 v[32:47], v[168:171], v[136:139], v[32:47]
    s_waitcnt lgkmcnt(2)
    s_mov_b32 s65, s46
    v_exp_f32 v115, v115
    v_exp_f32 v116, v116
    v_exp_f32 v117, v117
    v_exp_f32 v118, v118
    v_exp_f32 v119, v119
    v_cvt_pk_bf16_f32 v140, v112, v113
    v_cvt_pk_bf16_f32 v141, v114, v115
    v_cvt_pk_bf16_f32 v142, v116, v117
    v_cvt_pk_bf16_f32 v143, v118, v119
    v_mfma_f32_32x32x16_bf16 v[104:119], v[160:163], v[16:19], v[72:87]
    s_waitcnt lgkmcnt(1)
    v_exp_f32 v120, v120
    v_exp_f32 v121, v121
    v_exp_f32 v122, v122
    v_mfma_f32_32x32x16_bf16 v[32:47], v[172:175], v[140:143], v[32:47]
    s_add_u32 s39, s39, 16384
    v_exp_f32 v123, v123
    v_exp_f32 v124, v124
    v_exp_f32 v125, v125
    v_smfmac_f32_16x16x64_bf16 v[64:67], v[144:147], v[136:143], v148
    s_waitcnt lgkmcnt(0)
    v_exp_f32 v126, v126
    v_exp_f32 v127, v127
    v_cvt_pk_bf16_f32 v136, v120, v121
    v_cvt_pk_bf16_f32 v137, v122, v123
    v_cvt_pk_bf16_f32 v138, v124, v125
    v_cvt_pk_bf16_f32 v139, v126, v127
    v_mfma_f32_32x32x16_bf16 v[104:119], v[164:167], v[20:23], v[104:119]
    s_and_b32 s39, s39, 0x3ffff
    v_exp_f32 v128, v128
    v_exp_f32 v129, v129
    v_exp_f32 v130, v130
    v_mfma_f32_32x32x16_bf16 v[48:63], v[168:171], v[136:139], v[48:63]
    ds_read_b128 v[168:171], v2 offset:6144
    v_exp_f32 v131, v131
    v_exp_f32 v132, v132
    v_exp_f32 v133, v133
    v_exp_f32 v134, v134
    v_exp_f32 v135, v135
    v_cvt_pk_bf16_f32 v140, v128, v129
    v_cvt_pk_bf16_f32 v141, v130, v131
    v_cvt_pk_bf16_f32 v142, v132, v133
    v_cvt_pk_bf16_f32 v143, v134, v135
    v_mfma_f32_32x32x16_bf16 v[120:135], v[160:163], v[24:27], v[88:103]
    ds_read_b128 v[160:163], v2 offset:8192
    s_setprio 1
    v_exp_f32 v104, v104
    v_exp_f32 v105, v105
    v_exp_f32 v106, v106
    v_mfma_f32_32x32x16_bf16 v[48:63], v[172:175], v[140:143], v[48:63]
    ds_read_b128 v[172:175], v2 offset:7168
    v_exp_f32 v107, v107
    v_exp_f32 v108, v108
    v_exp_f32 v109, v109
    v_smfmac_f32_16x16x64_bf16 v[68:71], v[144:147], v[136:143], v148
    s_waitcnt lgkmcnt(2)
    v_exp_f32 v110, v110
    v_exp_f32 v111, v111
    v_cvt_pk_bf16_f32 v136, v104, v105
    v_cvt_pk_bf16_f32 v137, v106, v107
    v_cvt_pk_bf16_f32 v138, v108, v109
    v_cvt_pk_bf16_f32 v139, v110, v111
    v_mfma_f32_32x32x16_bf16 v[120:135], v[164:167], v[28:31], v[120:135]
    ds_read_b128 v[164:167], v2 offset:9216
    v_exp_f32 v112, v112
    v_exp_f32 v113, v113
    v_exp_f32 v114, v114
    v_mfma_f32_32x32x16_bf16 v[32:47], v[168:171], v[136:139], v[32:47]
    s_waitcnt lgkmcnt(2)
    v_exp_f32 v115, v115
    v_exp_f32 v116, v116
    v_exp_f32 v117, v117
    v_exp_f32 v118, v118
    v_exp_f32 v119, v119
    v_cvt_pk_bf16_f32 v140, v112, v113
    v_cvt_pk_bf16_f32 v141, v114, v115
    v_cvt_pk_bf16_f32 v142, v116, v117
    v_cvt_pk_bf16_f32 v143, v118, v119
    v_mfma_f32_32x32x16_bf16 v[104:119], v[160:163], v[16:19], v[72:87]
    s_waitcnt lgkmcnt(1)
    v_exp_f32 v120, v120
    v_exp_f32 v121, v121
    v_exp_f32 v122, v122
    v_mfma_f32_32x32x16_bf16 v[32:47], v[172:175], v[140:143], v[32:47]
    s_add_u32 s46, s46, 32768
    v_exp_f32 v123, v123
    v_exp_f32 v124, v124
    v_exp_f32 v125, v125
    v_smfmac_f32_16x16x64_bf16 v[64:67], v[144:147], v[136:143], v148
    s_waitcnt lgkmcnt(0)
    v_exp_f32 v126, v126
    v_exp_f32 v127, v127
    v_cvt_pk_bf16_f32 v136, v120, v121
    v_cvt_pk_bf16_f32 v137, v122, v123
    v_cvt_pk_bf16_f32 v138, v124, v125
    v_cvt_pk_bf16_f32 v139, v126, v127
    v_mfma_f32_32x32x16_bf16 v[104:119], v[164:167], v[20:23], v[104:119]
    s_and_b32 s46, s46, 0x1ffff
    v_exp_f32 v128, v128
    v_exp_f32 v129, v129
    v_exp_f32 v130, v130
    v_mfma_f32_32x32x16_bf16 v[48:63], v[168:171], v[136:139], v[48:63]
    ds_read_b128 v[168:171], v2 offset:10240
    v_exp_f32 v131, v131
    v_exp_f32 v132, v132
    v_exp_f32 v133, v133
    v_exp_f32 v134, v134
    v_exp_f32 v135, v135
    v_cvt_pk_bf16_f32 v140, v128, v129
    v_cvt_pk_bf16_f32 v141, v130, v131
    v_cvt_pk_bf16_f32 v142, v132, v133
    v_cvt_pk_bf16_f32 v143, v134, v135
    s_cmp_eq_u32 s28, 0
    s_cbranch_scc0 L_smp_19
    s_mov_b32 exec_lo, 0xffff
    s_mov_b32 exec_hi, 0
    buffer_load_dword v150, v149, s[16:19], s54 offen sc1
    s_mov_b64 exec, -1
    s_nop 3
L_smp_19:
    v_mfma_f32_32x32x16_bf16 v[120:135], v[160:163], v[24:27], v[88:103]
    ds_read_b128 v[160:163], v2 offset:12288
    s_setprio 0
    v_exp_f32 v104, v104
    v_exp_f32 v105, v105
    v_exp_f32 v106, v106
    v_mfma_f32_32x32x16_bf16 v[48:63], v[172:175], v[140:143], v[48:63]
    ds_read_b128 v[172:175], v2 offset:11264
    v_exp_f32 v107, v107
    v_exp_f32 v108, v108
    v_exp_f32 v109, v109
    v_smfmac_f32_16x16x64_bf16 v[68:71], v[144:147], v[136:143], v148
    s_waitcnt lgkmcnt(2)
    v_exp_f32 v110, v110
    v_exp_f32 v111, v111
    v_cvt_pk_bf16_f32 v136, v104, v105
    v_cvt_pk_bf16_f32 v137, v106, v107
    v_cvt_pk_bf16_f32 v138, v108, v109
    v_cvt_pk_bf16_f32 v139, v110, v111
    v_mfma_f32_32x32x16_bf16 v[120:135], v[164:167], v[28:31], v[120:135]
    ds_read_b128 v[164:167], v2 offset:13312
    v_exp_f32 v112, v112
    v_exp_f32 v113, v113
    v_exp_f32 v114, v114
    v_mfma_f32_32x32x16_bf16 v[32:47], v[168:171], v[136:139], v[32:47]
    s_waitcnt lgkmcnt(2)
    v_exp_f32 v115, v115
    v_exp_f32 v116, v116
    v_exp_f32 v117, v117
    v_exp_f32 v118, v118
    v_exp_f32 v119, v119
    v_cvt_pk_bf16_f32 v140, v112, v113
    v_cvt_pk_bf16_f32 v141, v114, v115
    v_cvt_pk_bf16_f32 v142, v116, v117
    v_cvt_pk_bf16_f32 v143, v118, v119
    v_mfma_f32_32x32x16_bf16 v[104:119], v[160:163], v[16:19], v[72:87]
    s_waitcnt lgkmcnt(1)
    v_exp_f32 v120, v120
    v_exp_f32 v121, v121
    v_exp_f32 v122, v122
    v_mfma_f32_32x32x16_bf16 v[32:47], v[172:175], v[140:143], v[32:47]
    s_add_u32 m0, s46, s55
    v_exp_f32 v123, v123
    v_exp_f32 v124, v124
    v_exp_f32 v125, v125
    v_smfmac_f32_16x16x64_bf16 v[64:67], v[144:147], v[136:143], v148
    s_waitcnt lgkmcnt(0)
    v_exp_f32 v126, v126
    v_exp_f32 v127, v127
    v_cvt_pk_bf16_f32 v136, v120, v121
    v_cvt_pk_bf16_f32 v137, v122, v123
    v_cvt_pk_bf16_f32 v138, v124, v125
    v_cvt_pk_bf16_f32 v139, v126, v127
    v_mfma_f32_32x32x16_bf16 v[104:119], v[164:167], v[20:23], v[104:119]
    s_add_u32 s38, s38, 1
    v_exp_f32 v128, v128
    v_exp_f32 v129, v129
    v_exp_f32 v130, v130
    v_mfma_f32_32x32x16_bf16 v[48:63], v[168:171], v[136:139], v[48:63]
    ds_read_b128 v[168:171], v2 offset:14336
    v_exp_f32 v131, v131
    v_exp_f32 v132, v132
    v_exp_f32 v133, v133
    v_exp_f32 v134, v134
    v_exp_f32 v135, v135
    v_cvt_pk_bf16_f32 v140, v128, v129
    v_cvt_pk_bf16_f32 v141, v130, v131
    v_cvt_pk_bf16_f32 v142, v132, v133
    v_cvt_pk_bf16_f32 v143, v134, v135
    s_cmp_eq_u32 s28, 0
    s_cbranch_scc0 L_go_20
    s_mov_b32 s41, 400000
    s_add_u32 s42, s32, 1
    s_and_b32 s42, s42, 7
    s_lshl_b32 s42, 1, s42
    s_mov_b32 s42, 65535
    s_mov_b64 exec, 0xffff
L_poll_21:
    s_waitcnt vmcnt(0)
    v_cmp_eq_u32 vcc, 1, v150
    s_nop 3
    s_and_b32 s43, vcc_lo, s42
    s_cmp_eq_u32 s43, s42
    s_cbranch_scc1 L_pdone_22
    s_sub_u32 s41, s41, 1
    s_cbranch_scc1 L_pdone_22
    buffer_load_dword v150, v149, s[16:19], s54 offen sc1
    s_branch L_poll_21
L_pdone_22:
    s_mov_b64 exec, -1
L_go_20:
    s_waitcnt vmcnt(4)
    s_barrier
    s_setprio 3
    v_mfma_f32_32x32x16_bf16 v[120:135], v[160:163], v[24:27], v[88:103]
    ds_read_b128 v[160:163], v3 offset:0
    v_exp_f32 v104, v104
    v_exp_f32 v105, v105
    v_exp_f32 v106, v106
    v_mfma_f32_32x32x16_bf16 v[48:63], v[172:175], v[140:143], v[48:63]
    ds_read_b128 v[172:175], v2 offset:15360
    v_exp_f32 v107, v107
    v_exp_f32 v108, v108
    v_exp_f32 v109, v109
    v_smfmac_f32_16x16x64_bf16 v[68:71], v[144:147], v[136:143], v148
    s_waitcnt lgkmcnt(2)
    buffer_load_dwordx4 v5, s[16:19], s39 offen offset:0 sc1 lds
    v_exp_f32 v110, v110
    v_exp_f32 v111, v111
    v_cvt_pk_bf16_f32 v136, v104, v105
    v_cvt_pk_bf16_f32 v137, v106, v107
    v_cvt_pk_bf16_f32 v138, v108, v109
    v_cvt_pk_bf16_f32 v139, v110, v111
    v_mfma_f32_32x32x16_bf16 v[120:135], v[164:167], v[28:31], v[120:135]
    ds_read_b128 v[164:167], v3 offset:1024
    v_exp_f32 v112, v112
    v_exp_f32 v113, v113
    v_exp_f32 v114, v114
    v_mfma_f32_32x32x16_bf16 v[32:47], v[168:171], v[136:139], v[32:47]
    s_waitcnt lgkmcnt(2)
    buffer_load_dwordx4 v5, s[16:19], s39 offen offset:1024 sc1 lds
    v_exp_f32 v115, v115
    v_exp_f32 v116, v116
    v_exp_f32 v117, v117
    v_exp_f32 v118, v118
    v_exp_f32 v119, v119
    v_cvt_pk_bf16_f32 v140, v112, v113
    v_cvt_pk_bf16_f32 v141, v114, v115
    v_cvt_pk_bf16_f32 v142, v116, v117
    v_cvt_pk_bf16_f32 v143, v118, v119
    v_mfma_f32_32x32x16_bf16 v[104:119], v[160:163], v[16:19], v[72:87]
    s_waitcnt lgkmcnt(1)
    v_exp_f32 v120, v120
    v_exp_f32 v121, v121
    v_exp_f32 v122, v122
    v_mfma_f32_32x32x16_bf16 v[32:47], v[172:175], v[140:143], v[32:47]
    buffer_load_dwordx4 v5, s[16:19], s39 offen offset:2048 sc1 lds
    v_exp_f32 v123, v123
    v_exp_f32 v124, v124
    v_exp_f32 v125, v125
    v_smfmac_f32_16x16x64_bf16 v[64:67], v[144:147], v[136:143], v148
    s_waitcnt lgkmcnt(0)
    v_exp_f32 v126, v126
    v_exp_f32 v127, v127
    v_cvt_pk_bf16_f32 v136, v120, v121
    v_cvt_pk_bf16_f32 v137, v122, v123
    v_cvt_pk_bf16_f32 v138, v124, v125
    v_cvt_pk_bf16_f32 v139, v126, v127
    v_mfma_f32_32x32x16_bf16 v[104:119], v[164:167], v[20:23], v[104:119]
    buffer_load_dwordx4 v5, s[16:19], s39 offen offset:3072 sc1 lds
    v_exp_f32 v128, v128
    v_exp_f32 v129, v129
    v_exp_f32 v130, v130
    v_mfma_f32_32x32x16_bf16 v[48:63], v[168:171], v[136:139], v[48:63]
    ds_read_b128 v[168:171], v3 offset:2048
    v_exp_f32 v131, v131
    v_exp_f32 v132, v132
    v_exp_f32 v133, v133
    v_exp_f32 v134, v134
    v_exp_f32 v135, v135
    v_cvt_pk_bf16_f32 v140, v128, v129
    v_cvt_pk_bf16_f32 v141, v130, v131
    v_cvt_pk_bf16_f32 v142, v132, v133
    v_cvt_pk_bf16_f32 v143, v134, v135
    v_mov_b32 v2, v3
    v_add_u32 v3, s65, v4
.p2align 6
L_attn_23:
    v_mfma_f32_32x32x16_bf16 v[120:135], v[160:163], v[24:27], v[88:103]
    ds_read_b128 v[160:163], v2 offset:4096
    s_setprio 2
    v_exp_f32 v104, v104
    v_exp_f32 v105, v105
    v_exp_f32 v106, v106
    v_mfma_f32_32x32x16_bf16 v[48:63], v[172:175], v[140:143], v[48:63]
    ds_read_b128 v[172:175], v2 offset:3072
    v_exp_f32 v107, v107
    v_exp_f32 v108, v108
    v_exp_f32 v109, v109
    v_smfmac_f32_16x16x64_bf16 v[68:71], v[144:147], v[136:143], v148
    s_waitcnt lgkmcnt(2)
    v_exp_f32 v110, v110
    v_exp_f32 v111, v111
    v_cvt_pk_bf16_f32 v136, v104, v105
    v_cvt_pk_bf16_f32 v137, v106, v107
    v_cvt_pk_bf16_f32 v138, v108, v109
    v_cvt_pk_bf16_f32 v139, v110, v111
    v_mfma_f32_32x32x16_bf16 v[120:135], v[164:167], v[28:31], v[120:135]
    ds_read_b128 v[164:167], v2 offset:5120
    v_exp_f32 v112, v112
    v_exp_f32 v113, v113
    v_exp_f32 v114, v114
    v_mfma_f32_32x32x16_bf16 v[32:47], v[168:171], v[136:139], v[32:47]
    s_waitcnt lgkmcnt(2)
    s_mov_b32 s65, s46
    v_exp_f32 v115, v115
    v_exp_f32 v116, v116
    v_exp_f32 v117, v117
    v_exp_f32 v118, v118
    v_exp_f32 v119, v119
    v_cvt_pk_bf16_f32 v140, v112, v113
    v_cvt_pk_bf16_f32 v141, v114, v115
    v_cvt_pk_bf16_f32 v142, v116, v117
    v_cvt_pk_bf16_f32 v143, v118, v119
    v_mfma_f32_32x32x16_bf16 v[104:119], v[160:163], v[16:19], v[72:87]
    s_waitcnt lgkmcnt(1)
    v_exp_f32 v120, v120
    v_exp_f32 v121, v121
    v_exp_f32 v122, v122
    v_mfma_f32_32x32x16_bf16 v[32:47], v[172:175], v[140:143], v[32:47]
    s_add_u32 s39, s39, 16384
    v_exp_f32 v123, v123
    v_exp_f32 v124, v124
    v_exp_f32 v125, v125
    v_smfmac_f32_16x16x64_bf16 v[64:67], v[144:147], v[136:143], v148
    s_waitcnt lgkmcnt(0)
    v_exp_f32 v126, v126
    v_exp_f32 v127, v127
    v_cvt_pk_bf16_f32 v136, v120, v121
    v_cvt_pk_bf16_f32 v137, v122, v123
    v_cvt_pk_bf16_f32 v138, v124, v125
    v_cvt_pk_bf16_f32 v139, v126, v127
    v_mfma_f32_32x32x16_bf16 v[104:119], v[164:167], v[20:23], v[104:119]
    s_and_b32 s39, s39, 0x3ffff
    v_exp_f32 v128, v128
    v_exp_f32 v129, v129
    v_exp_f32 v130, v130
    v_mfma_f32_32x32x16_bf16 v[48:63], v[168:171], v[136:139], v[48:63]
    ds_read_b128 v[168:171], v2 offset:6144
    v_exp_f32 v131, v131
    v_exp_f32 v132, v132
    v_exp_f32 v133, v133
    v_exp_f32 v134, v134
    v_exp_f32 v135, v135
    v_cvt_pk_bf16_f32 v140, v128, v129
    v_cvt_pk_bf16_f32 v141, v130, v131
    v_cvt_pk_bf16_f32 v142, v132, v133
    v_cvt_pk_bf16_f32 v143, v134, v135
    v_mfma_f32_32x32x16_bf16 v[120:135], v[160:163], v[24:27], v[88:103]
    ds_read_b128 v[160:163], v2 offset:8192
    s_setprio 1
    v_exp_f32 v104, v104
    v_exp_f32 v105, v105
    v_exp_f32 v106, v106
    v_mfma_f32_32x32x16_bf16 v[48:63], v[172:175], v[140:143], v[48:63]
    ds_read_b128 v[172:175], v2 offset:7168
    v_exp_f32 v107, v107
    v_exp_f32 v108, v108
    v_exp_f32 v109, v109
    v_smfmac_f32_16x16x64_bf16 v[68:71], v[144:147], v[136:143], v148
    s_waitcnt lgkmcnt(2)
    v_exp_f32 v110, v110
    v_exp_f32 v111, v111
    v_cvt_pk_bf16_f32 v136, v104, v105
    v_cvt_pk_bf16_f32 v137, v106, v107
    v_cvt_pk_bf16_f32 v138, v108, v109
    v_cvt_pk_bf16_f32 v139, v110, v111
    v_mfma_f32_32x32x16_bf16 v[120:135], v[164:167], v[28:31], v[120:135]
    ds_read_b128 v[164:167], v2 offset:9216
    v_exp_f32 v112, v112
    v_exp_f32 v113, v113
    v_exp_f32 v114, v114
    v_mfma_f32_32x32x16_bf16 v[32:47], v[168:171], v[136:139], v[32:47]
    s_waitcnt lgkmcnt(2)
    v_exp_f32 v115, v115
    v_exp_f32 v116, v116
    v_exp_f32 v117, v117
    v_exp_f32 v118, v118
    v_exp_f32 v119, v119
    v_cvt_pk_bf16_f32 v140, v112, v113
    v_cvt_pk_bf16_f32 v141, v114, v115
    v_cvt_pk_bf16_f32 v142, v116, v117
    v_cvt_pk_bf16_f32 v143, v118, v119
    v_mfma_f32_32x32x16_bf16 v[104:119], v[160:163], v[16:19], v[72:87]
    s_waitcnt lgkmcnt(1)
    v_exp_f32 v120, v120
    v_exp_f32 v121, v121
    v_exp_f32 v122, v122
    v_mfma_f32_32x32x16_bf16 v[32:47], v[172:175], v[140:143], v[32:47]
    s_add_u32 s46, s46, 32768
    v_exp_f32 v123, v123
    v_exp_f32 v124, v124
    v_exp_f32 v125, v125
    v_smfmac_f32_16x16x64_bf16 v[64:67], v[144:147], v[136:143], v148
    s_waitcnt lgkmcnt(0)
    v_exp_f32 v126, v126
    v_exp_f32 v127, v127
    v_cvt_pk_bf16_f32 v136, v120, v121
    v_cvt_pk_bf16_f32 v137, v122, v123
    v_cvt_pk_bf16_f32 v138, v124, v125
    v_cvt_pk_bf16_f32 v139, v126, v127
    v_mfma_f32_32x32x16_bf16 v[104:119], v[164:167], v[20:23], v[104:119]
    s_and_b32 s46, s46, 0x1ffff
    v_exp_f32 v128, v128
    v_exp_f32 v129, v129
    v_exp_f32 v130, v130
    v_mfma_f32_32x32x16_bf16 v[48:63], v[168:171], v[136:139], v[48:63]
    ds_read_b128 v[168:171], v2 offset:10240
    v_exp_f32 v131, v131
    v_exp_f32 v132, v132
    v_exp_f32 v133, v133
    v_exp_f32 v134, v134
    v_exp_f32 v135, v135
    v_cvt_pk_bf16_f32 v140, v128, v129
    v_cvt_pk_bf16_f32 v141, v130, v131
    v_cvt_pk_bf16_f32 v142, v132, v133
    v_cvt_pk_bf16_f32 v143, v134, v135
    v_mfma_f32_32x32x16_bf16 v[120:135], v[160:163], v[24:27], v[88:103]
    ds_read_b128 v[160:163], v2 offset:12288
    s_setprio 0
    v_exp_f32 v104, v104
    v_exp_f32 v105, v105
    v_exp_f32 v106, v106
    v_mfma_f32_32x32x16_bf16 v[48:63], v[172:175], v[140:143], v[48:63]
    ds_read_b128 v[172:175], v2 offset:11264
    v_exp_f32 v107, v107
    v_exp_f32 v108, v108
    v_exp_f32 v109, v109
    v_smfmac_f32_16x16x64_bf16 v[68:71], v[144:147], v[136:143], v148
    s_waitcnt lgkmcnt(2)
    v_exp_f32 v110, v110
    v_exp_f32 v111, v111
    v_cvt_pk_bf16_f32 v136, v104, v105
    v_cvt_pk_bf16_f32 v137, v106, v107
    v_cvt_pk_bf16_f32 v138, v108, v109
    v_cvt_pk_bf16_f32 v139, v110, v111
    v_mfma_f32_32x32x16_bf16 v[120:135], v[164:167], v[28:31], v[120:135]
    ds_read_b128 v[164:167], v2 offset:13312
    v_exp_f32 v112, v112
    v_exp_f32 v113, v113
    v_exp_f32 v114, v114
    v_mfma_f32_32x32x16_bf16 v[32:47], v[168:171], v[136:139], v[32:47]
    s_waitcnt lgkmcnt(2)
    v_exp_f32 v115, v115
    v_exp_f32 v116, v116
    v_exp_f32 v117, v117
    v_exp_f32 v118, v118
    v_exp_f32 v119, v119
    v_cvt_pk_bf16_f32 v140, v112, v113
    v_cvt_pk_bf16_f32 v141, v114, v115
    v_cvt_pk_bf16_f32 v142, v116, v117
    v_cvt_pk_bf16_f32 v143, v118, v119
    v_mfma_f32_32x32x16_bf16 v[104:119], v[160:163], v[16:19], v[72:87]
    s_waitcnt lgkmcnt(1)
    v_exp_f32 v120, v120
    v_exp_f32 v121, v121
    v_exp_f32 v122, v122
    v_mfma_f32_32x32x16_bf16 v[32:47], v[172:175], v[140:143], v[32:47]
    s_add_u32 m0, s46, s55
    v_exp_f32 v123, v123
    v_exp_f32 v124, v124
    v_exp_f32 v125, v125
    v_smfmac_f32_16x16x64_bf16 v[64:67], v[144:147], v[136:143], v148
    s_waitcnt lgkmcnt(0)
    v_exp_f32 v126, v126
    v_exp_f32 v127, v127
    v_cvt_pk_bf16_f32 v136, v120, v121
    v_cvt_pk_bf16_f32 v137, v122, v123
    v_cvt_pk_bf16_f32 v138, v124, v125
    v_cvt_pk_bf16_f32 v139, v126, v127
    v_mfma_f32_32x32x16_bf16 v[104:119], v[164:167], v[20:23], v[104:119]
    s_add_u32 s38, s38, 1
    v_exp_f32 v128, v128
    v_exp_f32 v129, v129
    v_exp_f32 v130, v130
    v_mfma_f32_32x32x16_bf16 v[48:63], v[168:171], v[136:139], v[48:63]
    ds_read_b128 v[168:171], v2 offset:14336
    s_waitcnt vmcnt(4)
    s_barrier
    s_setprio 3
    v_exp_f32 v131, v131
    v_exp_f32 v132, v132
    v_exp_f32 v133, v133
    v_exp_f32 v134, v134
    v_exp_f32 v135, v135
    v_cvt_pk_bf16_f32 v140, v128, v129
    v_cvt_pk_bf16_f32 v141, v130, v131
    v_cvt_pk_bf16_f32 v142, v132, v133
    v_cvt_pk_bf16_f32 v143, v134, v135
    v_mfma_f32_32x32x16_bf16 v[120:135], v[160:163], v[24:27], v[88:103]
    ds_read_b128 v[160:163], v3 offset:0
    v_exp_f32 v104, v104
    v_exp_f32 v105, v105
    v_exp_f32 v106, v106
    v_mfma_f32_32x32x16_bf16 v[48:63], v[172:175], v[140:143], v[48:63]
    ds_read_b128 v[172:175], v2 offset:15360
    v_exp_f32 v107, v107
    v_exp_f32 v108, v108
    v_exp_f32 v109, v109
    v_smfmac_f32_16x16x64_bf16 v[68:71], v[144:147], v[136:143], v148
    s_waitcnt lgkmcnt(2)
    buffer_load_dwordx4 v5, s[16:19], s39 offen offset:0 sc1 lds
    v_exp_f32 v110, v110
    v_exp_f32 v111, v111
    v_cvt_pk_bf16_f32 v136, v104, v105
    v_cvt_pk_bf16_f32 v137, v106, v107
    v_cvt_pk_bf16_f32 v138, v108, v109
    v_cvt_pk_bf16_f32 v139, v110, v111
    v_mfma_f32_32x32x16_bf16 v[120:135], v[164:167], v[28:31], v[120:135]
    ds_read_b128 v[164:167], v3 offset:1024
    v_exp_f32 v112, v112
    v_exp_f32 v113, v113
    v_exp_f32 v114, v114
    v_mfma_f32_32x32x16_bf16 v[32:47], v[168:171], v[136:139], v[32:47]
    s_waitcnt lgkmcnt(2)
    buffer_load_dwordx4 v5, s[16:19], s39 offen offset:1024 sc1 lds
    v_exp_f32 v115, v115
    v_exp_f32 v116, v116
    v_exp_f32 v117, v117
    v_exp_f32 v118, v118
    v_exp_f32 v119, v119
    v_cvt_pk_bf16_f32 v140, v112, v113
    v_cvt_pk_bf16_f32 v141, v114, v115
    v_cvt_pk_bf16_f32 v142, v116, v117
    v_cvt_pk_bf16_f32 v143, v118, v119
    v_mfma_f32_32x32x16_bf16 v[104:119], v[160:163], v[16:19], v[72:87]
    s_waitcnt lgkmcnt(1)
    v_exp_f32 v120, v120
    v_exp_f32 v121, v121
    v_exp_f32 v122, v122
    v_mfma_f32_32x32x16_bf16 v[32:47], v[172:175], v[140:143], v[32:47]
    buffer_load_dwordx4 v5, s[16:19], s39 offen offset:2048 sc1 lds
    v_exp_f32 v123, v123
    v_exp_f32 v124, v124
    v_exp_f32 v125, v125
    v_smfmac_f32_16x16x64_bf16 v[64:67], v[144:147], v[136:143], v148
    s_waitcnt lgkmcnt(0)
    v_exp_f32 v126, v126
    v_exp_f32 v127, v127
    v_cvt_pk_bf16_f32 v136, v120, v121
    v_cvt_pk_bf16_f32 v137, v122, v123
    v_cvt_pk_bf16_f32 v138, v124, v125
    v_cvt_pk_bf16_f32 v139, v126, v127
    v_mfma_f32_32x32x16_bf16 v[104:119], v[164:167], v[20:23], v[104:119]
    buffer_load_dwordx4 v5, s[16:19], s39 offen offset:3072 sc1 lds
    v_exp_f32 v128, v128
    v_exp_f32 v129, v129
    v_exp_f32 v130, v130
    v_mfma_f32_32x32x16_bf16 v[48:63], v[168:171], v[136:139], v[48:63]
    ds_read_b128 v[168:171], v3 offset:2048
    v_exp_f32 v131, v131
    v_exp_f32 v132, v132
    v_exp_f32 v133, v133
    v_exp_f32 v134, v134
    v_exp_f32 v135, v135
    v_cvt_pk_bf16_f32 v140, v128, v129
    v_cvt_pk_bf16_f32 v141, v130, v131
    v_cvt_pk_bf16_f32 v142, v132, v133
    v_cvt_pk_bf16_f32 v143, v134, v135
    v_mov_b32 v2, v3
    v_add_u32 v3, s65, v4
    s_cmp_lt_u32 s38, 13
    s_cbranch_scc1 L_attn_23
    v_mfma_f32_32x32x16_bf16 v[120:135], v[160:163], v[24:27], v[88:103]
    ds_read_b128 v[160:163], v2 offset:4096
    s_setprio 2
    v_exp_f32 v104, v104
    v_exp_f32 v105, v105
    v_exp_f32 v106, v106
    v_mfma_f32_32x32x16_bf16 v[48:63], v[172:175], v[140:143], v[48:63]
    ds_read_b128 v[172:175], v2 offset:3072
    v_exp_f32 v107, v107
    v_exp_f32 v108, v108
    v_exp_f32 v109, v109
    v_smfmac_f32_16x16x64_bf16 v[68:71], v[144:147], v[136:143], v148
    s_waitcnt lgkmcnt(2)
    v_exp_f32 v110, v110
    v_exp_f32 v111, v111
    v_cvt_pk_bf16_f32 v136, v104, v105
    v_cvt_pk_bf16_f32 v137, v106, v107
    v_cvt_pk_bf16_f32 v138, v108, v109
    v_cvt_pk_bf16_f32 v139, v110, v111
    v_mfma_f32_32x32x16_bf16 v[120:135], v[164:167], v[28:31], v[120:135]
    ds_read_b128 v[164:167], v2 offset:5120
    v_exp_f32 v112, v112
    v_exp_f32 v113, v113
    v_exp_f32 v114, v114
    v_mfma_f32_32x32x16_bf16 v[32:47], v[168:171], v[136:139], v[32:47]
    s_waitcnt lgkmcnt(2)
    s_mov_b32 s65, s46
    v_exp_f32 v115, v115
    v_exp_f32 v116, v116
    v_exp_f32 v117, v117
    v_exp_f32 v118, v118
    v_exp_f32 v119, v119
    v_cvt_pk_bf16_f32 v140, v112, v113
    v_cvt_pk_bf16_f32 v141, v114, v115
    v_cvt_pk_bf16_f32 v142, v116, v117
    v_cvt_pk_bf16_f32 v143, v118, v119
    v_mfma_f32_32x32x16_bf16 v[104:119], v[160:163], v[16:19], v[72:87]
    s_waitcnt lgkmcnt(1)
    v_exp_f32 v120, v120
    v_exp_f32 v121, v121
    v_exp_f32 v122, v122
    v_mfma_f32_32x32x16_bf16 v[32:47], v[172:175], v[140:143], v[32:47]
    s_add_u32 s39, s39, 16384
    v_exp_f32 v123, v123
    v_exp_f32 v124, v124
    v_exp_f32 v125, v125
    v_smfmac_f32_16x16x64_bf16 v[64:67], v[144:147], v[136:143], v148
    s_waitcnt lgkmcnt(0)
    v_exp_f32 v126, v126
    v_exp_f32 v127, v127
    v_cvt_pk_bf16_f32 v136, v120, v121
    v_cvt_pk_bf16_f32 v137, v122, v123
    v_cvt_pk_bf16_f32 v138, v124, v125
    v_cvt_pk_bf16_f32 v139, v126, v127
    v_mfma_f32_32x32x16_bf16 v[104:119], v[164:167], v[20:23], v[104:119]
    s_and_b32 s39, s39, 0x3ffff
    v_exp_f32 v128, v128
    v_exp_f32 v129, v129
    v_exp_f32 v130, v130
    v_mfma_f32_32x32x16_bf16 v[48:63], v[168:171], v[136:139], v[48:63]
    ds_read_b128 v[168:171], v2 offset:6144
    v_exp_f32 v131, v131
    v_exp_f32 v132, v132
    v_exp_f32 v133, v133
    v_exp_f32 v134, v134
    v_exp_f32 v135, v135
    v_cvt_pk_bf16_f32 v140, v128, v129
    v_cvt_pk_bf16_f32 v141, v130, v131
    v_cvt_pk_bf16_f32 v142, v132, v133
    v_cvt_pk_bf16_f32 v143, v134, v135
    v_mfma_f32_32x32x16_bf16 v[120:135], v[160:163], v[24:27], v[88:103]
    ds_read_b128 v[160:163], v2 offset:8192
    s_setprio 1
    v_exp_f32 v104, v104
    v_exp_f32 v105, v105
    v_exp_f32 v106, v106
    v_mfma_f32_32x32x16_bf16 v[48:63], v[172:175], v[140:143], v[48:63]
    ds_read_b128 v[172:175], v2 offset:7168
    v_exp_f32 v107, v107
    v_exp_f32 v108, v108
    v_exp_f32 v109, v109
    v_smfmac_f32_16x16x64_bf16 v[68:71], v[144:147], v[136:143], v148
    s_waitcnt lgkmcnt(2)
    s_add_u32 s40, s62, 8
    s_and_b32 s40, s40, 15
    s_lshl_b32 s40, s40, 17
    s_add_u32 s40, s40, s101
    s_add_u32 m0, s34, 131072
    s_nop 0
    buffer_load_dwordx4 v6, s[4:7], s40 offen lds
    v_exp_f32 v110, v110
    v_exp_f32 v111, v111
    v_cvt_pk_bf16_f32 v136, v104, v105
    v_cvt_pk_bf16_f32 v137, v106, v107
    v_cvt_pk_bf16_f32 v138, v108, v109
    v_cvt_pk_bf16_f32 v139, v110, v111
    v_mfma_f32_32x32x16_bf16 v[120:135], v[164:167], v[28:31], v[120:135]
    ds_read_b128 v[164:167], v2 offset:9216
    v_exp_f32 v112, v112
    v_exp_f32 v113, v113
    v_exp_f32 v114, v114
    v_mfma_f32_32x32x16_bf16 v[32:47], v[168:171], v[136:139], v[32:47]
    s_waitcnt lgkmcnt(2)
    s_add_u32 s40, s62, 8
    s_and_b32 s40, s40, 15
    s_lshl_b32 s40, s40, 17
    s_add_u32 s40, s40, s101
    s_add_u32 s40, s40, 16384
    s_add_u32 m0, s34, 132096
    s_nop 0
    buffer_load_dwordx4 v6, s[4:7], s40 offen lds
    v_exp_f32 v115, v115
    v_exp_f32 v116, v116
    v_exp_f32 v117, v117
    v_exp_f32 v118, v118
    v_exp_f32 v119, v119
    v_cvt_pk_bf16_f32 v140, v112, v113
    v_cvt_pk_bf16_f32 v141, v114, v115
    v_cvt_pk_bf16_f32 v142, v116, v117
    v_cvt_pk_bf16_f32 v143, v118, v119
    v_mfma_f32_32x32x16_bf16 v[104:119], v[160:163], v[16:19], v[72:87]
    s_waitcnt lgkmcnt(1)
    s_add_u32 s40, s62, 9
    s_and_b32 s40, s40, 15
    s_lshl_b32 s40, s40, 17
    s_add_u32 s40, s40, s101
    s_add_u32 m0, s34, 147456
    s_nop 0
    buffer_load_dwordx4 v6, s[4:7], s40 offen lds
    v_exp_f32 v120, v120
    v_exp_f32 v121, v121
    v_exp_f32 v122, v122
    v_mfma_f32_32x32x16_bf16 v[32:47], v[172:175], v[140:143], v[32:47]
    s_add_u32 s46, s46, 32768
    v_exp_f32 v123, v123
    v_exp_f32 v124, v124
    v_exp_f32 v125, v125
    v_smfmac_f32_16x16x64_bf16 v[64:67], v[144:147], v[136:143], v148
    s_waitcnt lgkmcnt(0)
    s_add_u32 s40, s62, 9
    s_and_b32 s40, s40, 15
    s_lshl_b32 s40, s40, 17
    s_add_u32 s40, s40, s101
    s_add_u32 s40, s40, 16384
    s_add_u32 m0, s34, 148480
    s_nop 0
    buffer_load_dwordx4 v6, s[4:7], s40 offen lds
    v_exp_f32 v126, v126
    v_exp_f32 v127, v127
    v_cvt_pk_bf16_f32 v136, v120, v121
    v_cvt_pk_bf16_f32 v137, v122, v123
    v_cvt_pk_bf16_f32 v138, v124, v125
    v_cvt_pk_bf16_f32 v139, v126, v127
    v_mfma_f32_32x32x16_bf16 v[104:119], v[164:167], v[20:23], v[104:119]
    s_and_b32 s46, s46, 0x1ffff
    v_exp_f32 v128, v128
    v_exp_f32 v129, v129
    v_exp_f32 v130, v130
    v_mfma_f32_32x32x16_bf16 v[48:63], v[168:171], v[136:139], v[48:63]
    ds_read_b128 v[168:171], v2 offset:10240
    v_exp_f32 v131, v131
    v_exp_f32 v132, v132
    v_exp_f32 v133, v133
    v_exp_f32 v134, v134
    v_exp_f32 v135, v135
    v_cvt_pk_bf16_f32 v140, v128, v129
    v_cvt_pk_bf16_f32 v141, v130, v131
    v_cvt_pk_bf16_f32 v142, v132, v133
    v_cvt_pk_bf16_f32 v143, v134, v135
    v_mfma_f32_32x32x16_bf16 v[120:135], v[160:163], v[24:27], v[88:103]
    ds_read_b128 v[160:163], v2 offset:12288
    s_setprio 0
    v_exp_f32 v104, v104
    v_exp_f32 v105, v105
    v_exp_f32 v106, v106
    v_mfma_f32_32x32x16_bf16 v[48:63], v[172:175], v[140:143], v[48:63]
    ds_read_b128 v[172:175], v2 offset:11264
    v_exp_f32 v107, v107
    v_exp_f32 v108, v108
    v_exp_f32 v109, v109
    v_smfmac_f32_16x16x64_bf16 v[68:71], v[144:147], v[136:143], v148
    s_waitcnt lgkmcnt(2)
    v_exp_f32 v110, v110
    v_exp_f32 v111, v111
    v_cvt_pk_bf16_f32 v136, v104, v105
    v_cvt_pk_bf16_f32 v137, v106, v107
    v_cvt_pk_bf16_f32 v138, v108, v109
    v_cvt_pk_bf16_f32 v139, v110, v111
    v_mfma_f32_32x32x16_bf16 v[120:135], v[164:167], v[28:31], v[120:135]
    ds_read_b128 v[164:167], v2 offset:13312
    v_exp_f32 v112, v112
    v_exp_f32 v113, v113
    v_exp_f32 v114, v114
    v_mfma_f32_32x32x16_bf16 v[32:47], v[168:171], v[136:139], v[32:47]
    s_waitcnt lgkmcnt(2)
    v_exp_f32 v115, v115
    v_exp_f32 v116, v116
    v_exp_f32 v117, v117
    v_exp_f32 v118, v118
    v_exp_f32 v119, v119
    v_cvt_pk_bf16_f32 v140, v112, v113
    v_cvt_pk_bf16_f32 v141, v114, v115
    v_cvt_pk_bf16_f32 v142, v116, v117
    v_cvt_pk_bf16_f32 v143, v118, v119
    v_mfma_f32_32x32x16_bf16 v[104:119], v[160:163], v[16:19], v[72:87]
    s_waitcnt lgkmcnt(1)
    v_exp_f32 v120, v120
    v_exp_f32 v121, v121
    v_exp_f32 v122, v122
    v_mfma_f32_32x32x16_bf16 v[32:47], v[172:175], v[140:143], v[32:47]
    s_add_u32 m0, s46, s55
    v_exp_f32 v123, v123
    v_exp_f32 v124, v124
    v_exp_f32 v125, v125
    v_smfmac_f32_16x16x64_bf16 v[64:67], v[144:147], v[136:143], v148
    s_waitcnt lgkmcnt(0)
    v_exp_f32 v126, v126
    v_exp_f32 v127, v127
    v_cvt_pk_bf16_f32 v136, v120, v121
    v_cvt_pk_bf16_f32 v137, v122, v123
    v_cvt_pk_bf16_f32 v138, v124, v125
    v_cvt_pk_bf16_f32 v139, v126, v127
    v_mfma_f32_32x32x16_bf16 v[104:119], v[164:167], v[20:23], v[104:119]
    s_add_u32 s38, s38, 1
    v_exp_f32 v128, v128
    v_exp_f32 v129, v129
    v_exp_f32 v130, v130
    v_mfma_f32_32x32x16_bf16 v[48:63], v[168:171], v[136:139], v[48:63]
    ds_read_b128 v[168:171], v2 offset:14336
    s_waitcnt vmcnt(8)
    s_barrier
    s_setprio 3
    v_exp_f32 v131, v131
    v_exp_f32 v132, v132
    v_exp_f32 v133, v133
    v_exp_f32 v134, v134
    v_exp_f32 v135, v135
    v_cvt_pk_bf16_f32 v140, v128, v129
    v_cvt_pk_bf16_f32 v141, v130, v131
    v_cvt_pk_bf16_f32 v142, v132, v133
    v_cvt_pk_bf16_f32 v143, v134, v135
    v_mfma_f32_32x32x16_bf16 v[120:135], v[160:163], v[24:27], v[88:103]
    ds_read_b128 v[160:163], v3 offset:0
    v_exp_f32 v104, v104
    v_exp_f32 v105, v105
    v_exp_f32 v106, v106
    v_mfma_f32_32x32x16_bf16 v[48:63], v[172:175], v[140:143], v[48:63]
    ds_read_b128 v[172:175], v2 offset:15360
    v_exp_f32 v107, v107
    v_exp_f32 v108, v108
    v_exp_f32 v109, v109
    v_smfmac_f32_16x16x64_bf16 v[68:71], v[144:147], v[136:143], v148
    s_waitcnt lgkmcnt(2)
    s_add_u32 s40, s62, 0
    s_and_b32 s40, s40, 15
    s_lshl_b32 s40, s40, 17
    s_add_u32 s40, s40, s101
    s_add_u32 m0, s34, 0
    s_nop 0
    buffer_load_dwordx4 v6, s[4:7], s40 offen lds
    v_exp_f32 v110, v110
    v_exp_f32 v111, v111
    v_cvt_pk_bf16_f32 v136, v104, v105
    v_cvt_pk_bf16_f32 v137, v106, v107
    v_cvt_pk_bf16_f32 v138, v108, v109
    v_cvt_pk_bf16_f32 v139, v110, v111
    v_mfma_f32_32x32x16_bf16 v[120:135], v[164:167], v[28:31], v[120:135]
    ds_read_b128 v[164:167], v3 offset:1024
    v_exp_f32 v112, v112
    v_exp_f32 v113, v113
    v_exp_f32 v114, v114
    v_mfma_f32_32x32x16_bf16 v[32:47], v[168:171], v[136:139], v[32:47]
    s_waitcnt lgkmcnt(2)
    s_add_u32 s40, s62, 0
    s_and_b32 s40, s40, 15
    s_lshl_b32 s40, s40, 17
    s_add_u32 s40, s40, s101
    s_add_u32 s40, s40, 16384
    s_add_u32 m0, s34, 1024
    s_nop 0
    buffer_load_dwordx4 v6, s[4:7], s40 offen lds
    v_exp_f32 v115, v115
    v_exp_f32 v116, v116
    v_exp_f32 v117, v117
    v_exp_f32 v118, v118
    v_exp_f32 v119, v119
    v_cvt_pk_bf16_f32 v140, v112, v113
    v_cvt_pk_bf16_f32 v141, v114, v115
    v_cvt_pk_bf16_f32 v142, v116, v117
    v_cvt_pk_bf16_f32 v143, v118, v119
    v_mfma_f32_32x32x16_bf16 v[104:119], v[160:163], v[16:19], v[72:87]
    s_waitcnt lgkmcnt(1)
    v_exp_f32 v120, v120
    v_exp_f32 v121, v121
    v_exp_f32 v122, v122
    v_mfma_f32_32x32x16_bf16 v[32:47], v[172:175], v[140:143], v[32:47]
    s_add_u32 s40, s62, 1
    s_and_b32 s40, s40, 15
    s_lshl_b32 s40, s40, 17
    s_add_u32 s40, s40, s101
    s_add_u32 m0, s34, 16384
    s_nop 0
    buffer_load_dwordx4 v6, s[4:7], s40 offen lds
    v_exp_f32 v123, v123
    v_exp_f32 v124, v124
    v_exp_f32 v125, v125
    v_smfmac_f32_16x16x64_bf16 v[64:67], v[144:147], v[136:143], v148
    s_waitcnt lgkmcnt(0)
    v_exp_f32 v126, v126
    v_exp_f32 v127, v127
    v_cvt_pk_bf16_f32 v136, v120, v121
    v_cvt_pk_bf16_f32 v137, v122, v123
    v_cvt_pk_bf16_f32 v138, v124, v125
    v_cvt_pk_bf16_f32 v139, v126, v127
    v_mfma_f32_32x32x16_bf16 v[104:119], v[164:167], v[20:23], v[104:119]
    s_add_u32 s40, s62, 1
    s_and_b32 s40, s40, 15
    s_lshl_b32 s40, s40, 17
    s_add_u32 s40, s40, s101
    s_add_u32 s40, s40, 16384
    s_add_u32 m0, s34, 17408
    s_nop 0
    buffer_load_dwordx4 v6, s[4:7], s40 offen lds
    v_exp_f32 v128, v128
    v_exp_f32 v129, v129
    v_exp_f32 v130, v130
    v_mfma_f32_32x32x16_bf16 v[48:63], v[168:171], v[136:139], v[48:63]
    ds_read_b128 v[168:171], v3 offset:2048
    v_exp_f32 v131, v131
    v_exp_f32 v132, v132
    v_exp_f32 v133, v133
    v_exp_f32 v134, v134
    v_exp_f32 v135, v135
    v_cvt_pk_bf16_f32 v140, v128, v129
    v_cvt_pk_bf16_f32 v141, v130, v131
    v_cvt_pk_bf16_f32 v142, v132, v133
    v_cvt_pk_bf16_f32 v143, v134, v135
    v_mov_b32 v2, v3
    v_add_u32 v3, s65, v4
    v_mfma_f32_32x32x16_bf16 v[120:135], v[160:163], v[24:27], v[88:103]
    ds_read_b128 v[160:163], v2 offset:4096
    s_setprio 2
    v_exp_f32 v104, v104
    v_exp_f32 v105, v105
    v_exp_f32 v106, v106
    v_mfma_f32_32x32x16_bf16 v[48:63], v[172:175], v[140:143], v[48:63]
    ds_read_b128 v[172:175], v2 offset:3072
    v_exp_f32 v107, v107
    v_exp_f32 v108, v108
    v_exp_f32 v109, v109
    v_smfmac_f32_16x16x64_bf16 v[68:71], v[144:147], v[136:143], v148
    s_waitcnt lgkmcnt(2)
    v_exp_f32 v110, v110
    v_exp_f32 v111, v111
    v_cvt_pk_bf16_f32 v136, v104, v105
    v_cvt_pk_bf16_f32 v137, v106, v107
    v_cvt_pk_bf16_f32 v138, v108, v109
    v_cvt_pk_bf16_f32 v139, v110, v111
    v_mfma_f32_32x32x16_bf16 v[120:135], v[164:167], v[28:31], v[120:135]
    ds_read_b128 v[164:167], v2 offset:5120
    v_exp_f32 v112, v112
    v_exp_f32 v113, v113
    v_exp_f32 v114, v114
    v_mfma_f32_32x32x16_bf16 v[32:47], v[168:171], v[136:139], v[32:47]
    s_waitcnt lgkmcnt(2)
    s_mov_b32 s65, s46
    v_exp_f32 v115, v115
    v_exp_f32 v116, v116
    v_exp_f32 v117, v117
    v_exp_f32 v118, v118
    v_exp_f32 v119, v119
    v_cvt_pk_bf16_f32 v140, v112, v113
    v_cvt_pk_bf16_f32 v141, v114, v115
    v_cvt_pk_bf16_f32 v142, v116, v117
    v_cvt_pk_bf16_f32 v143, v118, v119
    v_mfma_f32_32x32x16_bf16 v[104:119], v[160:163], v[16:19], v[72:87]
    s_waitcnt lgkmcnt(1)
    v_exp_f32 v120, v120
    v_exp_f32 v121, v121
    v_exp_f32 v122, v122
    v_mfma_f32_32x32x16_bf16 v[32:47], v[172:175], v[140:143], v[32:47]
    s_add_u32 s39, s39, 16384
    v_exp_f32 v123, v123
    v_exp_f32 v124, v124
    v_exp_f32 v125, v125
    v_smfmac_f32_16x16x64_bf16 v[64:67], v[144:147], v[136:143], v148
    s_waitcnt lgkmcnt(0)
    v_exp_f32 v126, v126
    v_exp_f32 v127, v127
    v_cvt_pk_bf16_f32 v136, v120, v121
    v_cvt_pk_bf16_f32 v137, v122, v123
    v_cvt_pk_bf16_f32 v138, v124, v125
    v_cvt_pk_bf16_f32 v139, v126, v127
    v_mfma_f32_32x32x16_bf16 v[104:119], v[164:167], v[20:23], v[104:119]
    s_and_b32 s39, s39, 0x3ffff
    v_exp_f32 v128, v128
    v_exp_f32 v129, v129
    v_exp_f32 v130, v130
    v_mfma_f32_32x32x16_bf16 v[48:63], v[168:171], v[136:139], v[48:63]
    ds_read_b128 v[168:171], v2 offset:6144
    v_exp_f32 v131, v131
    v_exp_f32 v132, v132
    v_exp_f32 v133, v133
    v_exp_f32 v134, v134
    v_exp_f32 v135, v135
    v_cvt_pk_bf16_f32 v140, v128, v129
    v_cvt_pk_bf16_f32 v141, v130, v131
    v_cvt_pk_bf16_f32 v142, v132, v133
    v_cvt_pk_bf16_f32 v143, v134, v135
    v_mfma_f32_32x32x16_bf16 v[120:135], v[160:163], v[24:27], v[88:103]
    ds_read_b128 v[160:163], v2 offset:8192
    s_setprio 1
    v_exp_f32 v104, v104
    v_exp_f32 v105, v105
    v_exp_f32 v106, v106
    v_mfma_f32_32x32x16_bf16 v[48:63], v[172:175], v[140:143], v[48:63]
    ds_read_b128 v[172:175], v2 offset:7168
    v_exp_f32 v107, v107
    v_exp_f32 v108, v108
    v_exp_f32 v109, v109
    v_smfmac_f32_16x16x64_bf16 v[68:71], v[144:147], v[136:143], v148
    s_waitcnt lgkmcnt(2)
    v_exp_f32 v110, v110
    v_exp_f32 v111, v111
    v_cvt_pk_bf16_f32 v136, v104, v105
    v_cvt_pk_bf16_f32 v137, v106, v107
    v_cvt_pk_bf16_f32 v138, v108, v109
    v_cvt_pk_bf16_f32 v139, v110, v111
    v_mfma_f32_32x32x16_bf16 v[120:135], v[164:167], v[28:31], v[120:135]
    ds_read_b128 v[164:167], v2 offset:9216
    v_exp_f32 v112, v112
    v_exp_f32 v113, v113
    v_exp_f32 v114, v114
    v_mfma_f32_32x32x16_bf16 v[32:47], v[168:171], v[136:139], v[32:47]
    s_waitcnt lgkmcnt(2)
    v_exp_f32 v115, v115
    v_exp_f32 v116, v116
    v_exp_f32 v117, v117
    v_exp_f32 v118, v118
    v_exp_f32 v119, v119
    v_cvt_pk_bf16_f32 v140, v112, v113
    v_cvt_pk_bf16_f32 v141, v114, v115
    v_cvt_pk_bf16_f32 v142, v116, v117
    v_cvt_pk_bf16_f32 v143, v118, v119
    v_mfma_f32_32x32x16_bf16 v[104:119], v[160:163], v[16:19], v[72:87]
    s_waitcnt lgkmcnt(1)
    v_exp_f32 v120, v120
    v_exp_f32 v121, v121
    v_exp_f32 v122, v122
    v_mfma_f32_32x32x16_bf16 v[32:47], v[172:175], v[140:143], v[32:47]
    s_add_u32 s46, s46, 32768
    v_exp_f32 v123, v123
    v_exp_f32 v124, v124
    v_exp_f32 v125, v125
    v_smfmac_f32_16x16x64_bf16 v[64:67], v[144:147], v[136:143], v148
    s_waitcnt lgkmcnt(0)
    v_exp_f32 v126, v126
    v_exp_f32 v127, v127
    v_cvt_pk_bf16_f32 v136, v120, v121
    v_cvt_pk_bf16_f32 v137, v122, v123
    v_cvt_pk_bf16_f32 v138, v124, v125
    v_cvt_pk_bf16_f32 v139, v126, v127
    v_mfma_f32_32x32x16_bf16 v[104:119], v[164:167], v[20:23], v[104:119]
    s_and_b32 s46, s46, 0x1ffff
    v_exp_f32 v128, v128
    v_exp_f32 v129, v129
    v_exp_f32 v130, v130
    v_mfma_f32_32x32x16_bf16 v[48:63], v[168:171], v[136:139], v[48:63]
    ds_read_b128 v[168:171], v2 offset:10240
    v_exp_f32 v131, v131
    v_exp_f32 v132, v132
    v_exp_f32 v133, v133
    v_exp_f32 v134, v134
    v_exp_f32 v135, v135
    v_cvt_pk_bf16_f32 v140, v128, v129
    v_cvt_pk_bf16_f32 v141, v130, v131
    v_cvt_pk_bf16_f32 v142, v132, v133
    v_cvt_pk_bf16_f32 v143, v134, v135
    v_mfma_f32_32x32x16_bf16 v[120:135], v[160:163], v[24:27], v[88:103]
    ds_read_b128 v[160:163], v2 offset:12288
    s_setprio 0
    v_exp_f32 v104, v104
    v_exp_f32 v105, v105
    v_exp_f32 v106, v106
    v_mfma_f32_32x32x16_bf16 v[48:63], v[172:175], v[140:143], v[48:63]
    ds_read_b128 v[172:175], v2 offset:11264
    v_exp_f32 v107, v107
    v_exp_f32 v108, v108
    v_exp_f32 v109, v109
    v_smfmac_f32_16x16x64_bf16 v[68:71], v[144:147], v[136:143], v148
    s_waitcnt lgkmcnt(2)
    v_exp_f32 v110, v110
    v_exp_f32 v111, v111
    v_cvt_pk_bf16_f32 v136, v104, v105
    v_cvt_pk_bf16_f32 v137, v106, v107
    v_cvt_pk_bf16_f32 v138, v108, v109
    v_cvt_pk_bf16_f32 v139, v110, v111
    v_mfma_f32_32x32x16_bf16 v[120:135], v[164:167], v[28:31], v[120:135]
    ds_read_b128 v[164:167], v2 offset:13312
    v_exp_f32 v112, v112
    v_exp_f32 v113, v113
    v_exp_f32 v114, v114
    v_mfma_f32_32x32x16_bf16 v[32:47], v[168:171], v[136:139], v[32:47]
    s_waitcnt lgkmcnt(2)
    v_exp_f32 v115, v115
    v_exp_f32 v116, v116
    v_exp_f32 v117, v117
    v_exp_f32 v118, v118
    v_exp_f32 v119, v119
    v_cvt_pk_bf16_f32 v140, v112, v113
    v_cvt_pk_bf16_f32 v141, v114, v115
    v_cvt_pk_bf16_f32 v142, v116, v117
    v_cvt_pk_bf16_f32 v143, v118, v119
    v_mfma_f32_32x32x16_bf16 v[104:119], v[160:163], v[16:19], v[72:87]
    s_waitcnt lgkmcnt(1)
    v_exp_f32 v120, v120
    v_exp_f32 v121, v121
    v_exp_f32 v122, v122
    v_mfma_f32_32x32x16_bf16 v[32:47], v[172:175], v[140:143], v[32:47]
    s_add_u32 m0, s46, s55
    v_exp_f32 v123, v123
    v_exp_f32 v124, v124
    v_exp_f32 v125, v125
    v_smfmac_f32_16x16x64_bf16 v[64:67], v[144:147], v[136:143], v148
    s_waitcnt lgkmcnt(0)
    v_exp_f32 v126, v126
    v_exp_f32 v127, v127
    v_cvt_pk_bf16_f32 v136, v120, v121
    v_cvt_pk_bf16_f32 v137, v122, v123
    v_cvt_pk_bf16_f32 v138, v124, v125
    v_cvt_pk_bf16_f32 v139, v126, v127
    v_mfma_f32_32x32x16_bf16 v[104:119], v[164:167], v[20:23], v[104:119]
    s_add_u32 s38, s38, 1
    v_exp_f32 v128, v128
    v_exp_f32 v129, v129
    v_exp_f32 v130, v130
    v_mfma_f32_32x32x16_bf16 v[48:63], v[168:171], v[136:139], v[48:63]
    ds_read_b128 v[168:171], v2 offset:14336
    s_waitcnt vmcnt(8)
    s_barrier
    s_setprio 3
    v_exp_f32 v131, v131
    v_exp_f32 v132, v132
    v_exp_f32 v133, v133
    v_exp_f32 v134, v134
    v_exp_f32 v135, v135
    v_cvt_pk_bf16_f32 v140, v128, v129
    v_cvt_pk_bf16_f32 v141, v130, v131
    v_cvt_pk_bf16_f32 v142, v132, v133
    v_cvt_pk_bf16_f32 v143, v134, v135
    v_mfma_f32_32x32x16_bf16 v[120:135], v[160:163], v[24:27], v[88:103]
    ds_read_b128 v[160:163], v3 offset:0
    v_exp_f32 v104, v104
    v_exp_f32 v105, v105
    v_exp_f32 v106, v106
    v_mfma_f32_32x32x16_bf16 v[48:63], v[172:175], v[140:143], v[48:63]
    ds_read_b128 v[172:175], v2 offset:15360
    v_exp_f32 v107, v107
    v_exp_f32 v108, v108
    v_exp_f32 v109, v109
    v_smfmac_f32_16x16x64_bf16 v[68:71], v[144:147], v[136:143], v148
    s_waitcnt lgkmcnt(2)
    s_add_u32 s40, s62, 2
    s_and_b32 s40, s40, 15
    s_lshl_b32 s40, s40, 17
    s_add_u32 s40, s40, s101
    s_add_u32 m0, s34, 32768
    s_nop 0
    buffer_load_dwordx4 v6, s[4:7], s40 offen lds
    v_exp_f32 v110, v110
    v_exp_f32 v111, v111
    v_cvt_pk_bf16_f32 v136, v104, v105
    v_cvt_pk_bf16_f32 v137, v106, v107
    v_cvt_pk_bf16_f32 v138, v108, v109
    v_cvt_pk_bf16_f32 v139, v110, v111
    v_mfma_f32_32x32x16_bf16 v[120:135], v[164:167], v[28:31], v[120:135]
    ds_read_b128 v[164:167], v3 offset:1024
    v_exp_f32 v112, v112
    v_exp_f32 v113, v113
    v_exp_f32 v114, v114
    v_mfma_f32_32x32x16_bf16 v[32:47], v[168:171], v[136:139], v[32:47]
    s_waitcnt lgkmcnt(2)
    s_add_u32 s40, s62, 2
    s_and_b32 s40, s40, 15
    s_lshl_b32 s40, s40, 17
    s_add_u32 s40, s40, s101
    s_add_u32 s40, s40, 16384
    s_add_u32 m0, s34, 33792
    s_nop 0
    buffer_load_dwordx4 v6, s[4:7], s40 offen lds
    v_exp_f32 v115, v115
    v_exp_f32 v116, v116
    v_exp_f32 v117, v117
    v_exp_f32 v118, v118
    v_exp_f32 v119, v119
    v_cvt_pk_bf16_f32 v140, v112, v113
    v_cvt_pk_bf16_f32 v141, v114, v115
    v_cvt_pk_bf16_f32 v142, v116, v117
    v_cvt_pk_bf16_f32 v143, v118, v119
    v_mfma_f32_32x32x16_bf16 v[104:119], v[160:163], v[16:19], v[72:87]
    s_waitcnt lgkmcnt(1)
    v_exp_f32 v120, v120
    v_exp_f32 v121, v121
    v_exp_f32 v122, v122
    v_mfma_f32_32x32x16_bf16 v[32:47], v[172:175], v[140:143], v[32:47]
    s_add_u32 s40, s62, 3
    s_and_b32 s40, s40, 15
    s_lshl_b32 s40, s40, 17
    s_add_u32 s40, s40, s101
    s_add_u32 m0, s34, 49152
    s_nop 0
    buffer_load_dwordx4 v6, s[4:7], s40 offen lds
    v_exp_f32 v123, v123
    v_exp_f32 v124, v124
    v_exp_f32 v125, v125
    v_smfmac_f32_16x16x64_bf16 v[64:67], v[144:147], v[136:143], v148
    s_waitcnt lgkmcnt(0)
    v_exp_f32 v126, v126
    v_exp_f32 v127, v127
    v_cvt_pk_bf16_f32 v136, v120, v121
    v_cvt_pk_bf16_f32 v137, v122, v123
    v_cvt_pk_bf16_f32 v138, v124, v125
    v_cvt_pk_bf16_f32 v139, v126, v127
    v_mfma_f32_32x32x16_bf16 v[104:119], v[164:167], v[20:23], v[104:119]
    s_add_u32 s40, s62, 3
    s_and_b32 s40, s40, 15
    s_lshl_b32 s40, s40, 17
    s_add_u32 s40, s40, s101
    s_add_u32 s40, s40, 16384
    s_add_u32 m0, s34, 50176
    s_nop 0
    buffer_load_dwordx4 v6, s[4:7], s40 offen lds
    v_exp_f32 v128, v128
    v_exp_f32 v129, v129
    v_exp_f32 v130, v130
    v_mfma_f32_32x32x16_bf16 v[48:63], v[168:171], v[136:139], v[48:63]
    ds_read_b128 v[168:171], v3 offset:2048
    v_exp_f32 v131, v131
    v_exp_f32 v132, v132
    v_exp_f32 v133, v133
    v_exp_f32 v134, v134
    v_exp_f32 v135, v135
    v_cvt_pk_bf16_f32 v140, v128, v129
    v_cvt_pk_bf16_f32 v141, v130, v131
    v_cvt_pk_bf16_f32 v142, v132, v133
    v_cvt_pk_bf16_f32 v143, v134, v135
    v_mov_b32 v2, v3
    v_add_u32 v3, s65, v4
    v_mfma_f32_32x32x16_bf16 v[120:135], v[160:163], v[24:27], v[88:103]
    ds_read_b128 v[160:163], v2 offset:4096
    s_setprio 2
    v_exp_f32 v104, v104
    v_exp_f32 v105, v105
    v_exp_f32 v106, v106
    v_mfma_f32_32x32x16_bf16 v[48:63], v[172:175], v[140:143], v[48:63]
    ds_read_b128 v[172:175], v2 offset:3072
    v_exp_f32 v107, v107
    v_exp_f32 v108, v108
    v_exp_f32 v109, v109
    v_smfmac_f32_16x16x64_bf16 v[68:71], v[144:147], v[136:143], v148
    s_waitcnt lgkmcnt(2)
    v_exp_f32 v110, v110
    v_exp_f32 v111, v111
    v_cvt_pk_bf16_f32 v136, v104, v105
    v_cvt_pk_bf16_f32 v137, v106, v107
    v_cvt_pk_bf16_f32 v138, v108, v109
    v_cvt_pk_bf16_f32 v139, v110, v111
    v_mfma_f32_32x32x16_bf16 v[120:135], v[164:167], v[28:31], v[120:135]
    ds_read_b128 v[164:167], v2 offset:5120
    v_exp_f32 v112, v112
    v_exp_f32 v113, v113
    v_exp_f32 v114, v114
    v_mfma_f32_32x32x16_bf16 v[32:47], v[168:171], v[136:139], v[32:47]
    s_waitcnt lgkmcnt(2)
    s_mov_b32 s65, s46
    v_exp_f32 v115, v115
    v_exp_f32 v116, v116
    v_exp_f32 v117, v117
    v_exp_f32 v118, v118
    v_exp_f32 v119, v119
    v_cvt_pk_bf16_f32 v140, v112, v113
    v_cvt_pk_bf16_f32 v141, v114, v115
    v_cvt_pk_bf16_f32 v142, v116, v117
    v_cvt_pk_bf16_f32 v143, v118, v119
    v_mfma_f32_32x32x16_bf16 v[104:119], v[160:163], v[16:19], v[72:87]
    s_waitcnt lgkmcnt(1)
    v_exp_f32 v120, v120
    v_exp_f32 v121, v121
    v_exp_f32 v122, v122
    v_mfma_f32_32x32x16_bf16 v[32:47], v[172:175], v[140:143], v[32:47]
    s_add_u32 s39, s39, 16384
    v_exp_f32 v123, v123
    v_exp_f32 v124, v124
    v_exp_f32 v125, v125
    v_smfmac_f32_16x16x64_bf16 v[64:67], v[144:147], v[136:143], v148
    s_waitcnt lgkmcnt(0)
    v_exp_f32 v126, v126
    v_exp_f32 v127, v127
    v_cvt_pk_bf16_f32 v136, v120, v121
    v_cvt_pk_bf16_f32 v137, v122, v123
    v_cvt_pk_bf16_f32 v138, v124, v125
    v_cvt_pk_bf16_f32 v139, v126, v127
    v_mfma_f32_32x32x16_bf16 v[104:119], v[164:167], v[20:23], v[104:119]
    s_and_b32 s39, s39, 0x3ffff
    v_exp_f32 v128, v128
    v_exp_f32 v129, v129
    v_exp_f32 v130, v130
    v_mfma_f32_32x32x16_bf16 v[48:63], v[168:171], v[136:139], v[48:63]
    ds_read_b128 v[168:171], v2 offset:6144
    v_exp_f32 v131, v131
    v_exp_f32 v132, v132
    v_exp_f32 v133, v133
    v_exp_f32 v134, v134
    v_exp_f32 v135, v135
    v_cvt_pk_bf16_f32 v140, v128, v129
    v_cvt_pk_bf16_f32 v141, v130, v131
    v_cvt_pk_bf16_f32 v142, v132, v133
    v_cvt_pk_bf16_f32 v143, v134, v135
    v_mfma_f32_32x32x16_bf16 v[120:135], v[160:163], v[24:27], v[88:103]
    ds_read_b128 v[160:163], v2 offset:8192
    s_setprio 1
    v_exp_f32 v104, v104
    v_exp_f32 v105, v105
    v_exp_f32 v106, v106
    v_mfma_f32_32x32x16_bf16 v[48:63], v[172:175], v[140:143], v[48:63]
    ds_read_b128 v[172:175], v2 offset:7168
    v_exp_f32 v107, v107
    v_exp_f32 v108, v108
    v_exp_f32 v109, v109
    v_smfmac_f32_16x16x64_bf16 v[68:71], v[144:147], v[136:143], v148
    s_waitcnt lgkmcnt(2)
    v_exp_f32 v110, v110
    v_exp_f32 v111, v111
    v_cvt_pk_bf16_f32 v136, v104, v105
    v_cvt_pk_bf16_f32 v137, v106, v107
    v_cvt_pk_bf16_f32 v138, v108, v109
    v_cvt_pk_bf16_f32 v139, v110, v111
    v_mfma_f32_32x32x16_bf16 v[120:135], v[164:167], v[28:31], v[120:135]
    ds_read_b128 v[164:167], v2 offset:9216
    v_exp_f32 v112, v112
    v_exp_f32 v113, v113
    v_exp_f32 v114, v114
    v_mfma_f32_32x32x16_bf16 v[32:47], v[168:171], v[136:139], v[32:47]
    s_waitcnt lgkmcnt(2)
    v_exp_f32 v115, v115
    v_exp_f32 v116, v116
    v_exp_f32 v117, v117
    v_exp_f32 v118, v118
    v_exp_f32 v119, v119
    v_cvt_pk_bf16_f32 v140, v112, v113
    v_cvt_pk_bf16_f32 v141, v114, v115
    v_cvt_pk_bf16_f32 v142, v116, v117
    v_cvt_pk_bf16_f32 v143, v118, v119
    v_mfma_f32_32x32x16_bf16 v[104:119], v[160:163], v[16:19], v[72:87]
    s_waitcnt lgkmcnt(1)
    v_exp_f32 v120, v120
    v_exp_f32 v121, v121
    v_exp_f32 v122, v122
    v_mfma_f32_32x32x16_bf16 v[32:47], v[172:175], v[140:143], v[32:47]
    s_add_u32 s46, s46, 32768
    v_exp_f32 v123, v123
    v_exp_f32 v124, v124
    v_exp_f32 v125, v125
    v_smfmac_f32_16x16x64_bf16 v[64:67], v[144:147], v[136:143], v148
    s_waitcnt lgkmcnt(0)
    v_exp_f32 v126, v126
    v_exp_f32 v127, v127
    v_cvt_pk_bf16_f32 v136, v120, v121
    v_cvt_pk_bf16_f32 v137, v122, v123
    v_cvt_pk_bf16_f32 v138, v124, v125
    v_cvt_pk_bf16_f32 v139, v126, v127
    v_mfma_f32_32x32x16_bf16 v[104:119], v[164:167], v[20:23], v[104:119]
    s_and_b32 s46, s46, 0x1ffff
    v_exp_f32 v128, v128
    v_exp_f32 v129, v129
    v_exp_f32 v130, v130
    v_mfma_f32_32x32x16_bf16 v[48:63], v[168:171], v[136:139], v[48:63]
    ds_read_b128 v[168:171], v2 offset:10240
    v_exp_f32 v131, v131
    v_exp_f32 v132, v132
    v_exp_f32 v133, v133
    v_exp_f32 v134, v134
    v_exp_f32 v135, v135
    v_cvt_pk_bf16_f32 v140, v128, v129
    v_cvt_pk_bf16_f32 v141, v130, v131
    v_cvt_pk_bf16_f32 v142, v132, v133
    v_cvt_pk_bf16_f32 v143, v134, v135
    v_mfma_f32_32x32x16_bf16 v[120:135], v[160:163], v[24:27], v[88:103]
    ds_read_b128 v[160:163], v2 offset:12288
    s_setprio 0
    v_exp_f32 v104, v104
    v_exp_f32 v105, v105
    v_exp_f32 v106, v106
    v_mfma_f32_32x32x16_bf16 v[48:63], v[172:175], v[140:143], v[48:63]
    ds_read_b128 v[172:175], v2 offset:11264
    v_exp_f32 v107, v107
    v_exp_f32 v108, v108
    v_exp_f32 v109, v109
    v_smfmac_f32_16x16x64_bf16 v[68:71], v[144:147], v[136:143], v148
    s_waitcnt lgkmcnt(2)
    v_exp_f32 v110, v110
    v_exp_f32 v111, v111
    v_cvt_pk_bf16_f32 v136, v104, v105
    v_cvt_pk_bf16_f32 v137, v106, v107
    v_cvt_pk_bf16_f32 v138, v108, v109
    v_cvt_pk_bf16_f32 v139, v110, v111
    v_mfma_f32_32x32x16_bf16 v[120:135], v[164:167], v[28:31], v[120:135]
    ds_read_b128 v[164:167], v2 offset:13312
    v_exp_f32 v112, v112
    v_exp_f32 v113, v113
    v_exp_f32 v114, v114
    v_mfma_f32_32x32x16_bf16 v[32:47], v[168:171], v[136:139], v[32:47]
    s_waitcnt lgkmcnt(2)
    v_exp_f32 v115, v115
    v_exp_f32 v116, v116
    v_exp_f32 v117, v117
    v_exp_f32 v118, v118
    v_exp_f32 v119, v119
    v_cvt_pk_bf16_f32 v140, v112, v113
    v_cvt_pk_bf16_f32 v141, v114, v115
    v_cvt_pk_bf16_f32 v142, v116, v117
    v_cvt_pk_bf16_f32 v143, v118, v119
    v_mfma_f32_32x32x16_bf16 v[104:119], v[160:163], v[16:19], v[72:87]
    s_waitcnt lgkmcnt(1)
    v_exp_f32 v120, v120
    v_exp_f32 v121, v121
    v_exp_f32 v122, v122
    v_mfma_f32_32x32x16_bf16 v[32:47], v[172:175], v[140:143], v[32:47]
    s_add_u32 m0, s46, s55
    v_exp_f32 v123, v123
    v_exp_f32 v124, v124
    v_exp_f32 v125, v125
    v_smfmac_f32_16x16x64_bf16 v[64:67], v[144:147], v[136:143], v148
    s_waitcnt lgkmcnt(0)
    v_exp_f32 v126, v126
    v_exp_f32 v127, v127
    v_cvt_pk_bf16_f32 v136, v120, v121
    v_cvt_pk_bf16_f32 v137, v122, v123
    v_cvt_pk_bf16_f32 v138, v124, v125
    v_cvt_pk_bf16_f32 v139, v126, v127
    v_mfma_f32_32x32x16_bf16 v[104:119], v[164:167], v[20:23], v[104:119]
    s_add_u32 s38, s38, 1
    v_exp_f32 v128, v128
    v_exp_f32 v129, v129
    v_exp_f32 v130, v130
    v_mfma_f32_32x32x16_bf16 v[48:63], v[168:171], v[136:139], v[48:63]
    ds_read_b128 v[168:171], v2 offset:14336
    s_barrier
    s_setprio 3
    v_exp_f32 v131, v131
    v_exp_f32 v132, v132
    v_exp_f32 v133, v133
    v_exp_f32 v134, v134
    v_exp_f32 v135, v135
    v_cvt_pk_bf16_f32 v140, v128, v129
    v_cvt_pk_bf16_f32 v141, v130, v131
    v_cvt_pk_bf16_f32 v142, v132, v133
    v_cvt_pk_bf16_f32 v143, v134, v135
    v_mfma_f32_32x32x16_bf16 v[120:135], v[160:163], v[24:27], v[88:103]
    ds_read_b128 v[160:163], v3 offset:0
    v_exp_f32 v104, v104
    v_exp_f32 v105, v105
    v_exp_f32 v106, v106
    v_mfma_f32_32x32x16_bf16 v[48:63], v[172:175], v[140:143], v[48:63]
    ds_read_b128 v[172:175], v2 offset:15360
    v_exp_f32 v107, v107
    v_exp_f32 v108, v108
    v_exp_f32 v109, v109
    v_smfmac_f32_16x16x64_bf16 v[68:71], v[144:147], v[136:143], v148
    s_waitcnt lgkmcnt(2)
    s_add_u32 s40, s62, 4
    s_and_b32 s40, s40, 15
    s_lshl_b32 s40, s40, 17
    s_add_u32 s40, s40, s101
    s_add_u32 m0, s34, 65536
    s_nop 0
    buffer_load_dwordx4 v6, s[4:7], s40 offen lds
    v_exp_f32 v110, v110
    v_exp_f32 v111, v111
    v_cvt_pk_bf16_f32 v136, v104, v105
    v_cvt_pk_bf16_f32 v137, v106, v107
    v_cvt_pk_bf16_f32 v138, v108, v109
    v_cvt_pk_bf16_f32 v139, v110, v111
    v_mfma_f32_32x32x16_bf16 v[120:135], v[164:167], v[28:31], v[120:135]
    ds_read_b128 v[164:167], v3 offset:1024
    v_exp_f32 v112, v112
    v_exp_f32 v113, v113
    v_exp_f32 v114, v114
    v_mfma_f32_32x32x16_bf16 v[32:47], v[168:171], v[136:139], v[32:47]
    s_waitcnt lgkmcnt(2)
    s_add_u32 s40, s62, 4
    s_and_b32 s40, s40, 15
    s_lshl_b32 s40, s40, 17
    s_add_u32 s40, s40, s101
    s_add_u32 s40, s40, 16384
    s_add_u32 m0, s34, 66560
    s_nop 0
    buffer_load_dwordx4 v6, s[4:7], s40 offen lds
    v_exp_f32 v115, v115
    v_exp_f32 v116, v116
    v_exp_f32 v117, v117
    v_exp_f32 v118, v118
    v_exp_f32 v119, v119
    v_cvt_pk_bf16_f32 v140, v112, v113
    v_cvt_pk_bf16_f32 v141, v114, v115
    v_cvt_pk_bf16_f32 v142, v116, v117
    v_cvt_pk_bf16_f32 v143, v118, v119
    v_mfma_f32_32x32x16_bf16 v[104:119], v[160:163], v[16:19], v[72:87]
    s_waitcnt lgkmcnt(1)
    v_exp_f32 v120, v120
    v_exp_f32 v121, v121
    v_exp_f32 v122, v122
    v_mfma_f32_32x32x16_bf16 v[32:47], v[172:175], v[140:143], v[32:47]
    s_add_u32 s40, s62, 5
    s_and_b32 s40, s40, 15
    s_lshl_b32 s40, s40, 17
    s_add_u32 s40, s40, s101
    s_add_u32 m0, s34, 81920
    s_nop 0
    buffer_load_dwordx4 v6, s[4:7], s40 offen lds
    v_exp_f32 v123, v123
    v_exp_f32 v124, v124
    v_exp_f32 v125, v125
    v_smfmac_f32_16x16x64_bf16 v[64:67], v[144:147], v[136:143], v148
    s_waitcnt lgkmcnt(0)
    v_exp_f32 v126, v126
    v_exp_f32 v127, v127
    v_cvt_pk_bf16_f32 v136, v120, v121
    v_cvt_pk_bf16_f32 v137, v122, v123
    v_cvt_pk_bf16_f32 v138, v124, v125
    v_cvt_pk_bf16_f32 v139, v126, v127
    v_mfma_f32_32x32x16_bf16 v[104:119], v[164:167], v[20:23], v[104:119]
    s_add_u32 s40, s62, 5
    s_and_b32 s40, s40, 15
    s_lshl_b32 s40, s40, 17
    s_add_u32 s40, s40, s101
    s_add_u32 s40, s40, 16384
    s_add_u32 m0, s34, 82944
    s_nop 0
    buffer_load_dwordx4 v6, s[4:7], s40 offen lds
    v_exp_f32 v128, v128
    v_exp_f32 v129, v129
    v_exp_f32 v130, v130
    v_mfma_f32_32x32x16_bf16 v[48:63], v[168:171], v[136:139], v[48:63]
    ds_read_b128 v[168:171], v3 offset:2048
    v_exp_f32 v131, v131
    v_exp_f32 v132, v132
    v_exp_f32 v133, v133
    v_exp_f32 v134, v134
    v_exp_f32 v135, v135
    v_cvt_pk_bf16_f32 v140, v128, v129
    v_cvt_pk_bf16_f32 v141, v130, v131
    v_cvt_pk_bf16_f32 v142, v132, v133
    v_cvt_pk_bf16_f32 v143, v134, v135
    v_mov_b32 v2, v3
    v_add_u32 v3, s65, v4
    s_setprio 0
    s_nop 1
    v_mfma_f32_32x32x16_bf16 v[48:63], v[172:175], v[140:143], v[48:63]
    v_smfmac_f32_16x16x64_bf16 v[68:71], v[144:147], v[136:143], v148
    s_waitcnt lgkmcnt(0)
    s_lshl_b32 s40, s32, 3
    s_lshl_b32 s41, s30, 1
    s_add_u32 s40, s40, s41
    s_lshl_b32 s40, s40, 17
    s_lshl_b32 s41, s31, 1
    s_add_u32 s41, s41, s29
    s_lshl_b32 s41, s41, 11
    s_add_u32 s40, s40, s41
    s_add_u32 s52, s40, 16777216
    s_mov_b32 s42, 0x4b800000
    s_nop 7
    v_mov_b32 v12, 0
    v_mov_b32 v13, 0
    v_add_f32 v64, v64, v65
    v_add_f32 v68, v68, v69
    v_pk_fma_f32 v[12:13], v[32:33], 0, v[12:13] op_sel_hi:[1,0,1]
    v_pk_fma_f32 v[12:13], v[34:35], 0, v[12:13] op_sel_hi:[1,0,1]
    v_pk_fma_f32 v[12:13], v[36:37], 0, v[12:13] op_sel_hi:[1,0,1]
    v_pk_fma_f32 v[12:13], v[38:39], 0, v[12:13] op_sel_hi:[1,0,1]
    v_pk_fma_f32 v[12:13], v[40:41], 0, v[12:13] op_sel_hi:[1,0,1]
    v_pk_fma_f32 v[12:13], v[42:43], 0, v[12:13] op_sel_hi:[1,0,1]
    v_pk_fma_f32 v[12:13], v[44:45], 0, v[12:13] op_sel_hi:[1,0,1]
    v_pk_fma_f32 v[12:13], v[46:47], 0, v[12:13] op_sel_hi:[1,0,1]
    v_pk_fma_f32 v[12:13], v[48:49], 0, v[12:13] op_sel_hi:[1,0,1]
    v_pk_fma_f32 v[12:13], v[50:51], 0, v[12:13] op_sel_hi:[1,0,1]
    v_pk_fma_f32 v[12:13], v[52:53], 0, v[12:13] op_sel_hi:[1,0,1]
    v_pk_fma_f32 v[12:13], v[54:55], 0, v[12:13] op_sel_hi:[1,0,1]
    v_pk_fma_f32 v[12:13], v[56:57], 0, v[12:13] op_sel_hi:[1,0,1]
    v_pk_fma_f32 v[12:13], v[58:59], 0, v[12:13] op_sel_hi:[1,0,1]
    v_pk_fma_f32 v[12:13], v[60:61], 0, v[12:13] op_sel_hi:[1,0,1]
    v_pk_fma_f32 v[12:13], v[62:63], 0, v[12:13] op_sel_hi:[1,0,1]
    v_cmp_nle_f32 s[48:49], v64, s42
    v_cmp_nle_f32 s[50:51], v68, s42
    v_cmp_u_f32 vcc, v12, v13
    s_or_b64 s[48:49], s[48:49], s[50:51]
    s_or_b64 s[48:49], s[48:49], vcc
    s_cmp_eq_u64 s[48:49], 0
    s_cbranch_scc1 L_ok_24
    s_lshl_b32 s40, s31, 1
    s_add_u32 s40, s40, s29
    s_lshl_b32 s47, s40, 18
    v_mov_b32 v32, 0
    v_mov_b32 v33, 0
    v_mov_b32 v34, 0
    v_mov_b32 v35, 0
    v_mov_b32 v36, 0
    v_mov_b32 v37, 0
    v_mov_b32 v38, 0
    v_mov_b32 v39, 0
    v_mov_b32 v40, 0
    v_mov_b32 v41, 0
    v_mov_b32 v42, 0
    v_mov_b32 v43, 0
    v_mov_b32 v44, 0
    v_mov_b32 v45, 0
    v_mov_b32 v46, 0
    v_mov_b32 v47, 0
    v_mov_b32 v48, 0
    v_mov_b32 v49, 0
    v_mov_b32 v50, 0
    v_mov_b32 v51, 0
    v_mov_b32 v52, 0
    v_mov_b32 v53, 0
    v_mov_b32 v54, 0
    v_mov_b32 v55, 0
    v_mov_b32 v56, 0
    v_mov_b32 v57, 0
    v_mov_b32 v58, 0
    v_mov_b32 v59, 0
    v_mov_b32 v60, 0
    v_mov_b32 v61, 0
    v_mov_b32 v62, 0
    v_mov_b32 v63, 0
    v_mov_b32 v64, 0
    v_mov_b32 v65, 0
    v_mov_b32 v66, 0
    v_mov_b32 v67, 0
    v_mov_b32 v68, 0
    v_mov_b32 v69, 0
    v_mov_b32 v70, 0
    v_mov_b32 v71, 0
    v_mov_b32 v72, 0xff800000
    v_mov_b32 v88, 0xff800000
    s_mov_b32 s38, 0
L_fb_25:
    buffer_load_dwordx4 v[160:163], v10, s[16:19], s47 offen sc1
    buffer_load_dwordx4 v[164:167], v10, s[16:19], s47 offen offset:1024 sc1
    buffer_load_dwordx4 v[168:171], v10, s[16:19], s47 offen offset:2048 sc1
    buffer_load_dwordx4 v[172:175], v10, s[16:19], s47 offen offset:3072 sc1
    s_waitcnt vmcnt(0)
    v_mfma_f32_32x32x16_bf16 v[104:119], v[160:163], v[16:19], 0
    v_mfma_f32_32x32x16_bf16 v[104:119], v[164:167], v[20:23], v[104:119]
    s_nop 15
    v_max3_f32 v12, v104, v105, v106
    v_max3_f32 v12, v12, v107, v108
    v_max3_f32 v12, v12, v109, v110
    v_max3_f32 v12, v12, v111, v112
    v_max3_f32 v12, v12, v113, v114
    v_max3_f32 v12, v12, v115, v116
    v_max3_f32 v12, v12, v117, v118
    v_max_f32 v12, v12, v119
    v_mov_b32 v13, v12
    s_nop 1
    v_permlane32_swap_b32 v13, v12
    s_nop 1
    v_max3_f32 v12, v12, v13, v72
    v_sub_f32 v13, v72, v12
    v_cmp_eq_f32 vcc, v72, v12
    v_exp_f32 v13, v13
    s_nop 1
    v_cndmask_b32 v13, v13, 1.0, vcc
    v_mov_b32 v72, v12
    v_mul_f32 v32, v13, v32
    v_mul_f32 v33, v13, v33
    v_mul_f32 v34, v13, v34
    v_mul_f32 v35, v13, v35
    v_mul_f32 v36, v13, v36
    v_mul_f32 v37, v13, v37
    v_mul_f32 v38, v13, v38
    v_mul_f32 v39, v13, v39
    v_mul_f32 v40, v13, v40
    v_mul_f32 v41, v13, v41
    v_mul_f32 v42, v13, v42
    v_mul_f32 v43, v13, v43
    v_mul_f32 v44, v13, v44
    v_mul_f32 v45, v13, v45
    v_mul_f32 v46, v13, v46
    v_mul_f32 v47, v13, v47
    v_mul_f32 v64, v13, v64
    v_mul_f32 v65, v13, v65
    v_mul_f32 v66, v13, v66
    v_mul_f32 v67, v13, v67
    v_sub_f32 v104, v104, v12
    v_sub_f32 v105, v105, v12
    v_sub_f32 v106, v106, v12
    v_sub_f32 v107, v107, v12
    v_sub_f32 v108, v108, v12
    v_sub_f32 v109, v109, v12
    v_sub_f32 v110, v110, v12
    v_sub_f32 v111, v111, v12
    v_sub_f32 v112, v112, v12
    v_sub_f32 v113, v113, v12
    v_sub_f32 v114, v114, v12
    v_sub_f32 v115, v115, v12
    v_sub_f32 v116, v116, v12
    v_sub_f32 v117, v117, v12
    v_sub_f32 v118, v118, v12
    v_sub_f32 v119, v119, v12
    v_exp_f32 v104, v104
    v_exp_f32 v105, v105
    v_exp_f32 v106, v106
    v_exp_f32 v107, v107
    v_exp_f32 v108, v108
    v_exp_f32 v109, v109
    v_exp_f32 v110, v110
    v_exp_f32 v111, v111
    v_exp_f32 v112, v112
    v_exp_f32 v113, v113
    v_exp_f32 v114, v114
    v_exp_f32 v115, v115
    v_exp_f32 v116, v116
    v_exp_f32 v117, v117
    v_exp_f32 v118, v118
    v_exp_f32 v119, v119
    s_nop 0
    v_cvt_pk_bf16_f32 v136, v104, v105
    v_cvt_pk_bf16_f32 v137, v106, v107
    v_cvt_pk_bf16_f32 v138, v108, v109
    v_cvt_pk_bf16_f32 v139, v110, v111
    v_cvt_pk_bf16_f32 v140, v112, v113
    v_cvt_pk_bf16_f32 v141, v114, v115
    v_cvt_pk_bf16_f32 v142, v116, v117
    v_cvt_pk_bf16_f32 v143, v118, v119
    s_nop 1
    v_mfma_f32_32x32x16_bf16 v[32:47], v[168:171], v[136:139], v[32:47]
    v_mfma_f32_32x32x16_bf16 v[32:47], v[172:175], v[140:143], v[32:47]
    v_smfmac_f32_16x16x64_bf16 v[64:67], v[144:147], v[136:143], v148
    s_nop 15
    v_mfma_f32_32x32x16_bf16 v[104:119], v[160:163], v[24:27], 0
    v_mfma_f32_32x32x16_bf16 v[104:119], v[164:167], v[28:31], v[104:119]
    s_nop 15
    v_max3_f32 v12, v104, v105, v106
    v_max3_f32 v12, v12, v107, v108
    v_max3_f32 v12, v12, v109, v110
    v_max3_f32 v12, v12, v111, v112
    v_max3_f32 v12, v12, v113, v114
    v_max3_f32 v12, v12, v115, v116
    v_max3_f32 v12, v12, v117, v118
    v_max_f32 v12, v12, v119
    v_mov_b32 v13, v12
    s_nop 1
    v_permlane32_swap_b32 v13, v12
    s_nop 1
    v_max3_f32 v12, v12, v13, v88
    v_sub_f32 v13, v88, v12
    v_cmp_eq_f32 vcc, v88, v12
    v_exp_f32 v13, v13
    s_nop 1
    v_cndmask_b32 v13, v13, 1.0, vcc
    v_mov_b32 v88, v12
    v_mul_f32 v48, v13, v48
    v_mul_f32 v49, v13, v49
    v_mul_f32 v50, v13, v50
    v_mul_f32 v51, v13, v51
    v_mul_f32 v52, v13, v52
    v_mul_f32 v53, v13, v53
    v_mul_f32 v54, v13, v54
    v_mul_f32 v55, v13, v55
    v_mul_f32 v56, v13, v56
    v_mul_f32 v57, v13, v57
    v_mul_f32 v58, v13, v58
    v_mul_f32 v59, v13, v59
    v_mul_f32 v60, v13, v60
    v_mul_f32 v61, v13, v61
    v_mul_f32 v62, v13, v62
    v_mul_f32 v63, v13, v63
    v_mul_f32 v68, v13, v68
    v_mul_f32 v69, v13, v69
    v_mul_f32 v70, v13, v70
    v_mul_f32 v71, v13, v71
    v_sub_f32 v104, v104, v12
    v_sub_f32 v105, v105, v12
    v_sub_f32 v106, v106, v12
    v_sub_f32 v107, v107, v12
    v_sub_f32 v108, v108, v12
    v_sub_f32 v109, v109, v12
    v_sub_f32 v110, v110, v12
    v_sub_f32 v111, v111, v12
    v_sub_f32 v112, v112, v12
    v_sub_f32 v113, v113, v12
    v_sub_f32 v114, v114, v12
    v_sub_f32 v115, v115, v12
    v_sub_f32 v116, v116, v12
    v_sub_f32 v117, v117, v12
    v_sub_f32 v118, v118, v12
    v_sub_f32 v119, v119, v12
    v_exp_f32 v104, v104
    v_exp_f32 v105, v105
    v_exp_f32 v106, v106
    v_exp_f32 v107, v107
    v_exp_f32 v108, v108
    v_exp_f32 v109, v109
    v_exp_f32 v110, v110
    v_exp_f32 v111, v111
    v_exp_f32 v112, v112
    v_exp_f32 v113, v113
    v_exp_f32 v114, v114
    v_exp_f32 v115, v115
    v_exp_f32 v116, v116
    v_exp_f32 v117, v117
    v_exp_f32 v118, v118
    v_exp_f32 v119, v119
    s_nop 0
    v_cvt_pk_bf16_f32 v136, v104, v105
    v_cvt_pk_bf16_f32 v137, v106, v107
    v_cvt_pk_bf16_f32 v138, v108, v109
    v_cvt_pk_bf16_f32 v139, v110, v111
    v_cvt_pk_bf16_f32 v140, v112, v113
    v_cvt_pk_bf16_f32 v141, v114, v115
    v_cvt_pk_bf16_f32 v142, v116, v117
    v_cvt_pk_bf16_f32 v143, v118, v119
    s_nop 1
    v_mfma_f32_32x32x16_bf16 v[48:63], v[168:171], v[136:139], v[48:63]
    v_mfma_f32_32x32x16_bf16 v[48:63], v[172:175], v[140:143], v[48:63]
    v_smfmac_f32_16x16x64_bf16 v[68:71], v[144:147], v[136:143], v148
    s_nop 15
    s_add_u32 s47, s47, 4096
    s_add_u32 s38, s38, 1
    s_cmp_lt_u32 s38, 64
    s_cbranch_scc1 L_fb_25
    v_add_f32 v64, v64, v65
    v_add_f32 v68, v68, v69
L_ok_24:
    v_rcp_f32 v12, v64
    v_rcp_f32 v14, v68
    v_mov_b32 v13, v12
    v_pk_mul_f32 v[32:33], v[32:33], v[12:13]
    v_pk_mul_f32 v[34:35], v[34:35], v[12:13]
    v_pk_mul_f32 v[36:37], v[36:37], v[12:13]
    v_pk_mul_f32 v[38:39], v[38:39], v[12:13]
    v_pk_mul_f32 v[40:41], v[40:41], v[12:13]
    v_pk_mul_f32 v[42:43], v[42:43], v[12:13]
    v_pk_mul_f32 v[44:45], v[44:45], v[12:13]
    v_pk_mul_f32 v[46:47], v[46:47], v[12:13]
    v_cvt_pk_bf16_f32 v32, v32, v33
    v_cvt_pk_bf16_f32 v33, v34, v35
    v_cvt_pk_bf16_f32 v34, v36, v37
    v_cvt_pk_bf16_f32 v35, v38, v39
    v_cvt_pk_bf16_f32 v36, v40, v41
    v_cvt_pk_bf16_f32 v37, v42, v43
    v_cvt_pk_bf16_f32 v38, v44, v45
    v_cvt_pk_bf16_f32 v39, v46, v47
    s_nop 1
    v_permlane16_swap_b32 v32, v36
    v_permlane16_swap_b32 v33, v37
    v_permlane16_swap_b32 v34, v38
    v_permlane16_swap_b32 v35, v39
    buffer_store_dwordx4 v[32:35], v10, s[16:19], s52 offen sc1
    buffer_store_dwordx4 v[36:39], v10, s[16:19], s52 offen offset:1024 sc1
    v_mov_b32 v15, v14
    v_pk_mul_f32 v[48:49], v[48:49], v[14:15]
    v_pk_mul_f32 v[50:51], v[50:51], v[14:15]
    v_pk_mul_f32 v[52:53], v[52:53], v[14:15]
    v_pk_mul_f32 v[54:55], v[54:55], v[14:15]
    v_pk_mul_f32 v[56:57], v[56:57], v[14:15]
    v_pk_mul_f32 v[58:59], v[58:59], v[14:15]
    v_pk_mul_f32 v[60:61], v[60:61], v[14:15]
    v_pk_mul_f32 v[62:63], v[62:63], v[14:15]
    v_cvt_pk_bf16_f32 v48, v48, v49
    v_cvt_pk_bf16_f32 v49, v50, v51
    v_cvt_pk_bf16_f32 v50, v52, v53
    v_cvt_pk_bf16_f32 v51, v54, v55
    v_cvt_pk_bf16_f32 v52, v56, v57
    v_cvt_pk_bf16_f32 v53, v58, v59
    v_cvt_pk_bf16_f32 v54, v60, v61
    v_cvt_pk_bf16_f32 v55, v62, v63
    s_nop 1
    v_permlane16_swap_b32 v48, v52
    v_permlane16_swap_b32 v49, v53
    v_permlane16_swap_b32 v50, v54
    v_permlane16_swap_b32 v51, v55
    s_add_u32 s52, s52, 131072
    buffer_store_dwordx4 v[48:51], v10, s[16:19], s52 offen sc1
    buffer_store_dwordx4 v[52:55], v10, s[16:19], s52 offen offset:1024 sc1
    s_cmp_eq_u32 s28, 0
    s_cbranch_scc0 L_smp_26
    s_mov_b32 exec_lo, 0xffffffff
    s_mov_b32 exec_hi, 0
    buffer_load_dword v150, v149, s[16:19], s63 offen sc1
    s_mov_b64 exec, -1
    s_nop 3
L_smp_26:
    s_waitcnt vmcnt(0)
    s_barrier
    s_cmp_eq_u32 s28, 0
    s_cbranch_scc0 L_np3_27
    s_lshl_b32 s40, s32, 12
    s_lshl_b32 s41, s31, 2
    s_add_u32 s40, s40, s41
    s_add_u32 s40, s40, 26279936
    v_lshlrev_b32 v12, 7, v0
    v_mov_b32 v15, 1
    s_mov_b32 exec_lo, -1
    s_mov_b32 exec_hi, 0
    buffer_store_dword v15, v12, s[16:19], s40 offen sc1
    s_mov_b64 exec, -1
    s_mov_b32 s40, 400000
    s_lshr_b32 s42, s60, 1
    s_cmp_eq_u32 s42, s32
    s_cselect_b32 s42, 1, 0
    s_lshl_b32 s42, s42, s31
    s_mov_b32 exec_lo, -1
    s_mov_b32 exec_hi, 0
L_poll3_28:
    v_cmp_eq_u32 vcc, 1, v150
    s_nop 3
    s_or_b32 s43, vcc_lo, s42
    s_cmp_eq_u32 s43, -1
    s_cbranch_scc1 L_pd3_29
    s_sub_u32 s40, s40, 1
    s_cbranch_scc1 L_pd3_29
    buffer_load_dword v150, v149, s[16:19], s63 offen sc1
    s_waitcnt vmcnt(0)
    s_branch L_poll3_28
L_pd3_29:
    s_mov_b64 exec, -1
    s_nop 3
L_np3_27:
    s_add_u32 s40, s62, 6
    s_and_b32 s40, s40, 15
    s_lshl_b32 s40, s40, 17
    s_add_u32 s40, s40, s101
    s_add_u32 m0, s34, 98304
    s_nop 0
    buffer_load_dwordx4 v6, s[4:7], s40 offen lds
    s_add_u32 s40, s62, 6
    s_and_b32 s40, s40, 15
    s_lshl_b32 s40, s40, 17
    s_add_u32 s40, s40, s101
    s_add_u32 s40, s40, 16384
    s_add_u32 m0, s34, 99328
    s_nop 0
    buffer_load_dwordx4 v6, s[4:7], s40 offen lds
    s_add_u32 s40, s62, 7
    s_and_b32 s40, s40, 15
    s_lshl_b32 s40, s40, 17
    s_add_u32 s40, s40, s101
    s_add_u32 m0, s34, 114688
    s_nop 0
    buffer_load_dwordx4 v6, s[4:7], s40 offen lds
    s_add_u32 s40, s62, 7
    s_and_b32 s40, s40, 15
    s_lshl_b32 s40, s40, 17
    s_add_u32 s40, s40, s101
    s_add_u32 s40, s40, 16384
    s_add_u32 m0, s34, 115712
    s_nop 0
    buffer_load_dwordx4 v6, s[4:7], s40 offen lds
    v_and_b32 v12, 15, v0
    s_lshl_b32 s40, s60, 7
    s_lshl_b32 s42, s30, 5
    s_add_u32 s40, s40, s42
    v_add_u32 v12, s40, v12
    v_lshlrev_b32 v3, 2, v12
    v_bfe_u32 v15, v0, 2, 2
    v_bfe_u32 v1, v0, 4, 1
    v_bfe_u32 v2, v0, 5, 1
    v_lshl_add_u32 v12, v2, 2, v15
    v_lshl_add_u32 v12, v1, 4, v12
    v_lshlrev_b32 v12, 7, v12
    v_bfe_u32 v2, v0, 1, 1
    v_lshrrev_b32 v15, 1, v15
    v_lshlrev_b32 v15, 2, v15
    v_xor_b32 v2, v2, v15
    v_lshlrev_b32 v1, 1, v1
    v_xor_b32 v2, v2, v1
    v_lshl_add_u32 v12, v2, 4, v12
    v_and_b32 v1, 1, v0
    v_lshl_add_u32 v12, v1, 3, v12
    s_lshl_b32 s40, s29, 13
    v_add_u32 v7, s40, v12
    v_xor_b32 v8, 32, v7
    v_xor_b32 v9, 64, v7
    v_xor_b32 v11, 96, v7
    v_add_u32 v4, 0x10000, v7
    v_add_u32 v5, 0x10000, v8
    v_add_u32 v152, 0x10000, v9
    v_add_u32 v153, 0x10000, v11
    v_add_u32 v154, 0x20000, v7
    v_add_u32 v155, 0x20000, v8
    v_add_u32 v156, 0x20000, v9
    v_add_u32 v157, 0x20000, v11
    s_lshl_b32 s40, s60, 2
    s_add_u32 s40, s40, s30
    s_lshl_b32 s100, s40, 17
    s_lshl_b32 s41, s29, 16
    s_add_u32 s100, s100, s41
    s_add_u32 s100, s100, 16777216
    s_barrier
    s_add_u32 s41, s62, 0
    s_and_b32 s41, s41, 15
    s_lshl_b32 s41, s41, 12
    s_add_u32 s41, s41, s100
    buffer_load_dwordx4 v[96:99], v10, s[16:19], s41 offen offset:0 sc1
    buffer_load_dwordx4 v[100:103], v10, s[16:19], s41 offen offset:1024 sc1
    buffer_load_dwordx4 v[104:107], v10, s[16:19], s41 offen offset:2048 sc1
    buffer_load_dwordx4 v[108:111], v10, s[16:19], s41 offen offset:3072 sc1
    s_add_u32 s41, s62, 1
    s_and_b32 s41, s41, 15
    s_lshl_b32 s41, s41, 12
    s_add_u32 s41, s41, s100
    buffer_load_dwordx4 v[112:115], v10, s[16:19], s41 offen offset:0 sc1
    buffer_load_dwordx4 v[116:119], v10, s[16:19], s41 offen offset:1024 sc1
    buffer_load_dwordx4 v[120:123], v10, s[16:19], s41 offen offset:2048 sc1
    buffer_load_dwordx4 v[124:127], v10, s[16:19], s41 offen offset:3072 sc1
    s_add_u32 s41, s62, 2
    s_and_b32 s41, s41, 15
    s_lshl_b32 s41, s41, 12
    s_add_u32 s41, s41, s100
    buffer_load_dwordx4 v[128:131], v10, s[16:19], s41 offen offset:0 sc1
    buffer_load_dwordx4 v[132:135], v10, s[16:19], s41 offen offset:1024 sc1
    buffer_load_dwordx4 v[136:139], v10, s[16:19], s41 offen offset:2048 sc1
    buffer_load_dwordx4 v[140:143], v10, s[16:19], s41 offen offset:3072 sc1
    s_mov_b32 s42, 25165824
    buffer_load_dword v14, v3, s[16:19], s42 offen sc1
    buffer_load_dword v158, v3, s[16:19], s42 offen offset:64 sc1
    ds_read_b64_tr_b16 v[48:49], v7 offset:0
    ds_read_b64_tr_b16 v[50:51], v7 offset:1024
    ds_read_b64_tr_b16 v[52:53], v8 offset:0
    ds_read_b64_tr_b16 v[54:55], v8 offset:1024
    ds_read_b64_tr_b16 v[56:57], v9 offset:0
    ds_read_b64_tr_b16 v[58:59], v9 offset:1024
    ds_read_b64_tr_b16 v[60:61], v11 offset:0
    ds_read_b64_tr_b16 v[62:63], v11 offset:1024
    ds_read_b64_tr_b16 v[64:65], v7 offset:4096
    ds_read_b64_tr_b16 v[66:67], v7 offset:5120
    ds_read_b64_tr_b16 v[68:69], v8 offset:4096
    ds_read_b64_tr_b16 v[70:71], v8 offset:5120
    ds_read_b64_tr_b16 v[72:73], v9 offset:4096
    ds_read_b64_tr_b16 v[74:75], v9 offset:5120
    ds_read_b64_tr_b16 v[76:77], v11 offset:4096
    ds_read_b64_tr_b16 v[78:79], v11 offset:5120
    s_waitcnt vmcnt(13) lgkmcnt(8)
    v_mfma_f32_16x16x32_bf16 v[16:19], v[48:51], v[96:99], 0
    ds_read_b64_tr_b16 v[80:81], v7 offset:16384
    v_mfma_f32_16x16x32_bf16 v[20:23], v[52:55], v[96:99], 0
    ds_read_b64_tr_b16 v[82:83], v7 offset:17408
    v_mfma_f32_16x16x32_bf16 v[24:27], v[56:59], v[96:99], 0
    ds_read_b64_tr_b16 v[84:85], v8 offset:16384
    v_mfma_f32_16x16x32_bf16 v[28:31], v[60:63], v[96:99], 0
    ds_read_b64_tr_b16 v[86:87], v8 offset:17408
    s_add_u32 s41, s62, 3
    s_and_b32 s41, s41, 15
    s_lshl_b32 s41, s41, 12
    s_add_u32 s41, s41, s100
    buffer_load_dwordx4 v[96:99], v10, s[16:19], s41 offen offset:0 sc1
    s_waitcnt vmcnt(13)
    v_mfma_f32_16x16x32_bf16 v[32:35], v[48:51], v[100:103], 0
    ds_read_b64_tr_b16 v[88:89], v9 offset:16384
    v_mfma_f32_16x16x32_bf16 v[36:39], v[52:55], v[100:103], 0
    ds_read_b64_tr_b16 v[90:91], v9 offset:17408
    v_mfma_f32_16x16x32_bf16 v[40:43], v[56:59], v[100:103], 0
    ds_read_b64_tr_b16 v[92:93], v11 offset:16384
    v_mfma_f32_16x16x32_bf16 v[44:47], v[60:63], v[100:103], 0
    ds_read_b64_tr_b16 v[94:95], v11 offset:17408
    buffer_load_dwordx4 v[100:103], v10, s[16:19], s41 offen offset:1024 sc1
    s_waitcnt vmcnt(13) lgkmcnt(8)
    v_mfma_f32_16x16x32_bf16 v[16:19], v[64:67], v[104:107], v[16:19]
    ds_read_b64_tr_b16 v[48:49], v7 offset:20480
    v_mfma_f32_16x16x32_bf16 v[20:23], v[68:71], v[104:107], v[20:23]
    ds_read_b64_tr_b16 v[50:51], v7 offset:21504
    v_mfma_f32_16x16x32_bf16 v[24:27], v[72:75], v[104:107], v[24:27]
    ds_read_b64_tr_b16 v[52:53], v8 offset:20480
    v_mfma_f32_16x16x32_bf16 v[28:31], v[76:79], v[104:107], v[28:31]
    ds_read_b64_tr_b16 v[54:55], v8 offset:21504
    buffer_load_dwordx4 v[104:107], v10, s[16:19], s41 offen offset:2048 sc1
    s_waitcnt vmcnt(13)
    v_mfma_f32_16x16x32_bf16 v[32:35], v[64:67], v[108:111], v[32:35]
    ds_read_b64_tr_b16 v[56:57], v9 offset:20480
    v_mfma_f32_16x16x32_bf16 v[36:39], v[68:71], v[108:111], v[36:39]
    ds_read_b64_tr_b16 v[58:59], v9 offset:21504
    v_mfma_f32_16x16x32_bf16 v[40:43], v[72:75], v[108:111], v[40:43]
    ds_read_b64_tr_b16 v[60:61], v11 offset:20480
    v_mfma_f32_16x16x32_bf16 v[44:47], v[76:79], v[108:111], v[44:47]
    ds_read_b64_tr_b16 v[62:63], v11 offset:21504
    buffer_load_dwordx4 v[108:111], v10, s[16:19], s41 offen offset:3072 sc1
    s_waitcnt vmcnt(13) lgkmcnt(8)
    v_mfma_f32_16x16x32_bf16 v[16:19], v[80:83], v[112:115], v[16:19]
    ds_read_b64_tr_b16 v[64:65], v7 offset:32768
    v_mfma_f32_16x16x32_bf16 v[20:23], v[84:87], v[112:115], v[20:23]
    ds_read_b64_tr_b16 v[66:67], v7 offset:33792
    v_mfma_f32_16x16x32_bf16 v[24:27], v[88:91], v[112:115], v[24:27]
    ds_read_b64_tr_b16 v[68:69], v8 offset:32768
    v_mfma_f32_16x16x32_bf16 v[28:31], v[92:95], v[112:115], v[28:31]
    ds_read_b64_tr_b16 v[70:71], v8 offset:33792
    s_add_u32 s41, s62, 4
    s_and_b32 s41, s41, 15
    s_lshl_b32 s41, s41, 12
    s_add_u32 s41, s41, s100
    buffer_load_dwordx4 v[112:115], v10, s[16:19], s41 offen offset:0 sc1
    s_waitcnt vmcnt(13)
    v_mfma_f32_16x16x32_bf16 v[32:35], v[80:83], v[116:119], v[32:35]
    ds_read_b64_tr_b16 v[72:73], v9 offset:32768
    v_mfma_f32_16x16x32_bf16 v[36:39], v[84:87], v[116:119], v[36:39]
    ds_read_b64_tr_b16 v[74:75], v9 offset:33792
    v_mfma_f32_16x16x32_bf16 v[40:43], v[88:91], v[116:119], v[40:43]
    ds_read_b64_tr_b16 v[76:77], v11 offset:32768
    v_mfma_f32_16x16x32_bf16 v[44:47], v[92:95], v[116:119], v[44:47]
    ds_read_b64_tr_b16 v[78:79], v11 offset:33792
    buffer_load_dwordx4 v[116:119], v10, s[16:19], s41 offen offset:1024 sc1
    s_waitcnt vmcnt(13) lgkmcnt(8)
    v_mfma_f32_16x16x32_bf16 v[16:19], v[48:51], v[120:123], v[16:19]
    ds_read_b64_tr_b16 v[80:81], v7 offset:36864
    v_mfma_f32_16x16x32_bf16 v[20:23], v[52:55], v[120:123], v[20:23]
    ds_read_b64_tr_b16 v[82:83], v7 offset:37888
    v_mfma_f32_16x16x32_bf16 v[24:27], v[56:59], v[120:123], v[24:27]
    ds_read_b64_tr_b16 v[84:85], v8 offset:36864
    v_mfma_f32_16x16x32_bf16 v[28:31], v[60:63], v[120:123], v[28:31]
    ds_read_b64_tr_b16 v[86:87], v8 offset:37888
    buffer_load_dwordx4 v[120:123], v10, s[16:19], s41 offen offset:2048 sc1
    s_waitcnt vmcnt(13)
    v_mfma_f32_16x16x32_bf16 v[32:35], v[48:51], v[124:127], v[32:35]
    ds_read_b64_tr_b16 v[88:89], v9 offset:36864
    v_mfma_f32_16x16x32_bf16 v[36:39], v[52:55], v[124:127], v[36:39]
    ds_read_b64_tr_b16 v[90:91], v9 offset:37888
    v_mfma_f32_16x16x32_bf16 v[40:43], v[56:59], v[124:127], v[40:43]
    ds_read_b64_tr_b16 v[92:93], v11 offset:36864
    v_mfma_f32_16x16x32_bf16 v[44:47], v[60:63], v[124:127], v[44:47]
    ds_read_b64_tr_b16 v[94:95], v11 offset:37888
    buffer_load_dwordx4 v[124:127], v10, s[16:19], s41 offen offset:3072 sc1
    s_waitcnt vmcnt(13) lgkmcnt(8)
    v_mfma_f32_16x16x32_bf16 v[16:19], v[64:67], v[128:131], v[16:19]
    ds_read_b64_tr_b16 v[48:49], v7 offset:49152
    v_mfma_f32_16x16x32_bf16 v[20:23], v[68:71], v[128:131], v[20:23]
    ds_read_b64_tr_b16 v[50:51], v7 offset:50176
    v_mfma_f32_16x16x32_bf16 v[24:27], v[72:75], v[128:131], v[24:27]
    ds_read_b64_tr_b16 v[52:53], v8 offset:49152
    v_mfma_f32_16x16x32_bf16 v[28:31], v[76:79], v[128:131], v[28:31]
    ds_read_b64_tr_b16 v[54:55], v8 offset:50176
    s_add_u32 s41, s62, 5
    s_and_b32 s41, s41, 15
    s_lshl_b32 s41, s41, 12
    s_add_u32 s41, s41, s100
    buffer_load_dwordx4 v[128:131], v10, s[16:19], s41 offen offset:0 sc1
    s_waitcnt vmcnt(13)
    v_mfma_f32_16x16x32_bf16 v[32:35], v[64:67], v[132:135], v[32:35]
    ds_read_b64_tr_b16 v[56:57], v9 offset:49152
    v_mfma_f32_16x16x32_bf16 v[36:39], v[68:71], v[132:135], v[36:39]
    ds_read_b64_tr_b16 v[58:59], v9 offset:50176
    v_mfma_f32_16x16x32_bf16 v[40:43], v[72:75], v[132:135], v[40:43]
    ds_read_b64_tr_b16 v[60:61], v11 offset:49152
    v_mfma_f32_16x16x32_bf16 v[44:47], v[76:79], v[132:135], v[44:47]
    ds_read_b64_tr_b16 v[62:63], v11 offset:50176
    buffer_load_dwordx4 v[132:135], v10, s[16:19], s41 offen offset:1024 sc1
    v_and_b32 v12, 15, v0
    v_lshrrev_b32 v1, 5, v0
    v_and_b32 v3, 7, v12
    v_xor_b32 v1, v1, v3
    s_waitcnt vmcnt(13) lgkmcnt(8)
    v_mfma_f32_16x16x32_bf16 v[16:19], v[80:83], v[136:139], v[16:19]
    ds_read_b64_tr_b16 v[64:65], v7 offset:53248
    v_mfma_f32_16x16x32_bf16 v[20:23], v[84:87], v[136:139], v[20:23]
    ds_read_b64_tr_b16 v[66:67], v7 offset:54272
    v_mfma_f32_16x16x32_bf16 v[24:27], v[88:91], v[136:139], v[24:27]
    ds_read_b64_tr_b16 v[68:69], v8 offset:53248
    v_mfma_f32_16x16x32_bf16 v[28:31], v[92:95], v[136:139], v[28:31]
    ds_read_b64_tr_b16 v[70:71], v8 offset:54272
    buffer_load_dwordx4 v[136:139], v10, s[16:19], s41 offen offset:2048 sc1
    s_waitcnt vmcnt(13)
    v_mfma_f32_16x16x32_bf16 v[32:35], v[80:83], v[140:143], v[32:35]
    ds_read_b64_tr_b16 v[72:73], v9 offset:53248
    v_mfma_f32_16x16x32_bf16 v[36:39], v[84:87], v[140:143], v[36:39]
    ds_read_b64_tr_b16 v[74:75], v9 offset:54272
    v_mfma_f32_16x16x32_bf16 v[40:43], v[88:91], v[140:143], v[40:43]
    ds_read_b64_tr_b16 v[76:77], v11 offset:53248
    v_mfma_f32_16x16x32_bf16 v[44:47], v[92:95], v[140:143], v[44:47]
    ds_read_b64_tr_b16 v[78:79], v11 offset:54272
    buffer_load_dwordx4 v[140:143], v10, s[16:19], s41 offen offset:3072 sc1
    s_lshl_b32 s40, s29, 14
    s_lshl_b32 s42, s30, 12
    s_add_u32 s40, s40, s42
    s_add_u32 s40, s40, 98304
    v_lshlrev_b32 v12, 7, v12
    v_lshl_add_u32 v12, v1, 4, v12
    s_waitcnt vmcnt(11) lgkmcnt(8)
    v_mfma_f32_16x16x32_bf16 v[16:19], v[48:51], v[96:99], v[16:19]
    ds_read_b64_tr_b16 v[80:81], v4 offset:0
    v_mfma_f32_16x16x32_bf16 v[20:23], v[52:55], v[96:99], v[20:23]
    ds_read_b64_tr_b16 v[82:83], v4 offset:1024
    v_mfma_f32_16x16x32_bf16 v[24:27], v[56:59], v[96:99], v[24:27]
    ds_read_b64_tr_b16 v[84:85], v5 offset:0
    v_mfma_f32_16x16x32_bf16 v[28:31], v[60:63], v[96:99], v[28:31]
    ds_read_b64_tr_b16 v[86:87], v5 offset:1024
    s_add_u32 s41, s62, 6
    s_and_b32 s41, s41, 15
    s_lshl_b32 s41, s41, 12
    s_add_u32 s41, s41, s100
    buffer_load_dwordx4 v[96:99], v10, s[16:19], s41 offen offset:0 sc1
    s_waitcnt vmcnt(11)
    v_mfma_f32_16x16x32_bf16 v[32:35], v[48:51], v[100:103], v[32:35]
    ds_read_b64_tr_b16 v[88:89], v152 offset:0
    v_mfma_f32_16x16x32_bf16 v[36:39], v[52:55], v[100:103], v[36:39]
    ds_read_b64_tr_b16 v[90:91], v152 offset:1024
    v_mfma_f32_16x16x32_bf16 v[40:43], v[56:59], v[100:103], v[40:43]
    ds_read_b64_tr_b16 v[92:93], v153 offset:0
    v_mfma_f32_16x16x32_bf16 v[44:47], v[60:63], v[100:103], v[44:47]
    ds_read_b64_tr_b16 v[94:95], v153 offset:1024
    buffer_load_dwordx4 v[100:103], v10, s[16:19], s41 offen offset:1024 sc1
    v_bfe_u32 v1, v0, 4, 1
    v_lshl_add_u32 v12, v1, 3, v12
    v_add_u32 v160, s40, v12
    s_waitcnt vmcnt(11) lgkmcnt(8)
    v_mfma_f32_16x16x32_bf16 v[16:19], v[64:67], v[104:107], v[16:19]
    ds_read_b64_tr_b16 v[48:49], v4 offset:4096
    v_mfma_f32_16x16x32_bf16 v[20:23], v[68:71], v[104:107], v[20:23]
    ds_read_b64_tr_b16 v[50:51], v4 offset:5120
    v_mfma_f32_16x16x32_bf16 v[24:27], v[72:75], v[104:107], v[24:27]
    ds_read_b64_tr_b16 v[52:53], v5 offset:4096
    v_mfma_f32_16x16x32_bf16 v[28:31], v[76:79], v[104:107], v[28:31]
    ds_read_b64_tr_b16 v[54:55], v5 offset:5120
    buffer_load_dwordx4 v[104:107], v10, s[16:19], s41 offen offset:2048 sc1
    s_waitcnt vmcnt(11)
    v_mfma_f32_16x16x32_bf16 v[32:35], v[64:67], v[108:111], v[32:35]
    ds_read_b64_tr_b16 v[56:57], v152 offset:4096
    v_mfma_f32_16x16x32_bf16 v[36:39], v[68:71], v[108:111], v[36:39]
    ds_read_b64_tr_b16 v[58:59], v152 offset:5120
    v_mfma_f32_16x16x32_bf16 v[40:43], v[72:75], v[108:111], v[40:43]
    ds_read_b64_tr_b16 v[60:61], v153 offset:4096
    v_mfma_f32_16x16x32_bf16 v[44:47], v[76:79], v[108:111], v[44:47]
    ds_read_b64_tr_b16 v[62:63], v153 offset:5120
    buffer_load_dwordx4 v[108:111], v10, s[16:19], s41 offen offset:3072 sc1
    v_xor_b32 v161, 32, v160
    v_xor_b32 v162, 64, v160
    v_xor_b32 v163, 96, v160
    s_waitcnt vmcnt(11) lgkmcnt(8)
    v_mfma_f32_16x16x32_bf16 v[16:19], v[80:83], v[112:115], v[16:19]
    ds_read_b64_tr_b16 v[64:65], v4 offset:16384
    v_mfma_f32_16x16x32_bf16 v[20:23], v[84:87], v[112:115], v[20:23]
    ds_read_b64_tr_b16 v[66:67], v4 offset:17408
    v_mfma_f32_16x16x32_bf16 v[24:27], v[88:91], v[112:115], v[24:27]
    ds_read_b64_tr_b16 v[68:69], v5 offset:16384
    v_mfma_f32_16x16x32_bf16 v[28:31], v[92:95], v[112:115], v[28:31]
    ds_read_b64_tr_b16 v[70:71], v5 offset:17408
    s_add_u32 s41, s62, 7
    s_and_b32 s41, s41, 15
    s_lshl_b32 s41, s41, 12
    s_add_u32 s41, s41, s100
    buffer_load_dwordx4 v[112:115], v10, s[16:19], s41 offen offset:0 sc1
    s_waitcnt vmcnt(11)
    v_mfma_f32_16x16x32_bf16 v[32:35], v[80:83], v[116:119], v[32:35]
    ds_read_b64_tr_b16 v[72:73], v152 offset:16384
    v_mfma_f32_16x16x32_bf16 v[36:39], v[84:87], v[116:119], v[36:39]
    ds_read_b64_tr_b16 v[74:75], v152 offset:17408
    v_mfma_f32_16x16x32_bf16 v[40:43], v[88:91], v[116:119], v[40:43]
    ds_read_b64_tr_b16 v[76:77], v153 offset:16384
    v_mfma_f32_16x16x32_bf16 v[44:47], v[92:95], v[116:119], v[44:47]
    ds_read_b64_tr_b16 v[78:79], v153 offset:17408
    buffer_load_dwordx4 v[116:119], v10, s[16:19], s41 offen offset:1024 sc1
    v_lshrrev_b32 v1, 3, v0
    v_and_b32 v3, 7, v0
    v_xor_b32 v2, v3, v1
    s_lshl_b32 s40, s28, 4
    v_add_u32 v1, s40, v1
    s_waitcnt vmcnt(11) lgkmcnt(8)
    v_mfma_f32_16x16x32_bf16 v[16:19], v[48:51], v[120:123], v[16:19]
    ds_read_b64_tr_b16 v[80:81], v4 offset:20480
    v_mfma_f32_16x16x32_bf16 v[20:23], v[52:55], v[120:123], v[20:23]
    ds_read_b64_tr_b16 v[82:83], v4 offset:21504
    v_mfma_f32_16x16x32_bf16 v[24:27], v[56:59], v[120:123], v[24:27]
    ds_read_b64_tr_b16 v[84:85], v5 offset:20480
    v_mfma_f32_16x16x32_bf16 v[28:31], v[60:63], v[120:123], v[28:31]
    ds_read_b64_tr_b16 v[86:87], v5 offset:21504
    buffer_load_dwordx4 v[120:123], v10, s[16:19], s41 offen offset:2048 sc1
    s_waitcnt vmcnt(11)
    v_mfma_f32_16x16x32_bf16 v[32:35], v[48:51], v[124:127], v[32:35]
    ds_read_b64_tr_b16 v[88:89], v152 offset:20480
    v_mfma_f32_16x16x32_bf16 v[36:39], v[52:55], v[124:127], v[36:39]
    ds_read_b64_tr_b16 v[90:91], v152 offset:21504
    v_mfma_f32_16x16x32_bf16 v[40:43], v[56:59], v[124:127], v[40:43]
    ds_read_b64_tr_b16 v[92:93], v153 offset:20480
    v_mfma_f32_16x16x32_bf16 v[44:47], v[60:63], v[124:127], v[44:47]
    ds_read_b64_tr_b16 v[94:95], v153 offset:21504
    buffer_load_dwordx4 v[124:127], v10, s[16:19], s41 offen offset:3072 sc1
    v_lshlrev_b32 v12, 7, v1
    v_lshl_add_u32 v12, v2, 4, v12
    v_add_u32 v164, 98304, v12
    s_waitcnt vmcnt(11) lgkmcnt(0)
    s_barrier
    v_mfma_f32_16x16x32_bf16 v[16:19], v[64:67], v[128:131], v[16:19]
    ds_read_b64_tr_b16 v[48:49], v4 offset:32768
    v_mfma_f32_16x16x32_bf16 v[20:23], v[68:71], v[128:131], v[20:23]
    ds_read_b64_tr_b16 v[50:51], v4 offset:33792
    v_mfma_f32_16x16x32_bf16 v[24:27], v[72:75], v[128:131], v[24:27]
    ds_read_b64_tr_b16 v[52:53], v5 offset:32768
    v_mfma_f32_16x16x32_bf16 v[28:31], v[76:79], v[128:131], v[28:31]
    ds_read_b64_tr_b16 v[54:55], v5 offset:33792
    s_add_u32 s41, s62, 8
    s_and_b32 s41, s41, 15
    s_lshl_b32 s41, s41, 12
    s_add_u32 s41, s41, s100
    buffer_load_dwordx4 v[128:131], v10, s[16:19], s41 offen offset:0 sc1
    s_add_u32 s40, s62, 10
    s_and_b32 s40, s40, 15
    s_lshl_b32 s40, s40, 17
    s_add_u32 s40, s40, s101
    s_add_u32 m0, s34, 0
    s_nop 0
    buffer_load_dwordx4 v6, s[4:7], s40 offen lds
    s_waitcnt vmcnt(12)
    v_mfma_f32_16x16x32_bf16 v[32:35], v[64:67], v[132:135], v[32:35]
    ds_read_b64_tr_b16 v[56:57], v152 offset:32768
    v_mfma_f32_16x16x32_bf16 v[36:39], v[68:71], v[132:135], v[36:39]
    ds_read_b64_tr_b16 v[58:59], v152 offset:33792
    v_mfma_f32_16x16x32_bf16 v[40:43], v[72:75], v[132:135], v[40:43]
    ds_read_b64_tr_b16 v[60:61], v153 offset:32768
    v_mfma_f32_16x16x32_bf16 v[44:47], v[76:79], v[132:135], v[44:47]
    ds_read_b64_tr_b16 v[62:63], v153 offset:33792
    buffer_load_dwordx4 v[132:135], v10, s[16:19], s41 offen offset:1024 sc1
    s_lshl_b32 s40, s60, 7
    v_add_u32 v1, s40, v1
    v_lshlrev_b32 v13, 11, v1
    v_lshl_add_u32 v13, v3, 4, v13
    s_add_u32 s40, s62, 10
    s_and_b32 s40, s40, 15
    s_lshl_b32 s40, s40, 17
    s_add_u32 s40, s40, s101
    s_add_u32 s40, s40, 16384
    s_add_u32 m0, s34, 1024
    s_nop 0
    buffer_load_dwordx4 v6, s[4:7], s40 offen lds
    s_waitcnt vmcnt(13) lgkmcnt(8)
    v_mfma_f32_16x16x32_bf16 v[16:19], v[80:83], v[136:139], v[16:19]
    ds_read_b64_tr_b16 v[64:65], v4 offset:36864
    v_mfma_f32_16x16x32_bf16 v[20:23], v[84:87], v[136:139], v[20:23]
    ds_read_b64_tr_b16 v[66:67], v4 offset:37888
    v_mfma_f32_16x16x32_bf16 v[24:27], v[88:91], v[136:139], v[24:27]
    ds_read_b64_tr_b16 v[68:69], v5 offset:36864
    v_mfma_f32_16x16x32_bf16 v[28:31], v[92:95], v[136:139], v[28:31]
    ds_read_b64_tr_b16 v[70:71], v5 offset:37888
    buffer_load_dwordx4 v[136:139], v10, s[16:19], s41 offen offset:2048 sc1
    s_add_u32 s40, s62, 11
    s_and_b32 s40, s40, 15
    s_lshl_b32 s40, s40, 17
    s_add_u32 s40, s40, s101
    s_add_u32 m0, s34, 16384
    s_nop 0
    buffer_load_dwordx4 v6, s[4:7], s40 offen lds
    s_waitcnt vmcnt(14)
    v_mfma_f32_16x16x32_bf16 v[32:35], v[80:83], v[140:143], v[32:35]
    ds_read_b64_tr_b16 v[72:73], v152 offset:36864
    v_mfma_f32_16x16x32_bf16 v[36:39], v[84:87], v[140:143], v[36:39]
    ds_read_b64_tr_b16 v[74:75], v152 offset:37888
    v_mfma_f32_16x16x32_bf16 v[40:43], v[88:91], v[140:143], v[40:43]
    ds_read_b64_tr_b16 v[76:77], v153 offset:36864
    v_mfma_f32_16x16x32_bf16 v[44:47], v[92:95], v[140:143], v[44:47]
    ds_read_b64_tr_b16 v[78:79], v153 offset:37888
    buffer_load_dwordx4 v[140:143], v10, s[16:19], s41 offen offset:3072 sc1
    s_add_u32 s40, s62, 11
    s_and_b32 s40, s40, 15
    s_lshl_b32 s40, s40, 17
    s_add_u32 s40, s40, s101
    s_add_u32 s40, s40, 16384
    s_add_u32 m0, s34, 17408
    s_nop 0
    buffer_load_dwordx4 v6, s[4:7], s40 offen lds
    s_waitcnt vmcnt(15) lgkmcnt(8)
    v_mfma_f32_16x16x32_bf16 v[16:19], v[48:51], v[96:99], v[16:19]
    ds_read_b64_tr_b16 v[80:81], v4 offset:49152
    v_mfma_f32_16x16x32_bf16 v[20:23], v[52:55], v[96:99], v[20:23]
    ds_read_b64_tr_b16 v[82:83], v4 offset:50176
    v_mfma_f32_16x16x32_bf16 v[24:27], v[56:59], v[96:99], v[24:27]
    ds_read_b64_tr_b16 v[84:85], v5 offset:49152
    v_mfma_f32_16x16x32_bf16 v[28:31], v[60:63], v[96:99], v[28:31]
    ds_read_b64_tr_b16 v[86:87], v5 offset:50176
    s_add_u32 s41, s62, 9
    s_and_b32 s41, s41, 15
    s_lshl_b32 s41, s41, 12
    s_add_u32 s41, s41, s100
    buffer_load_dwordx4 v[96:99], v10, s[16:19], s41 offen offset:0 sc1
    s_add_u32 s40, s62, 12
    s_and_b32 s40, s40, 15
    s_lshl_b32 s40, s40, 17
    s_add_u32 s40, s40, s101
    s_add_u32 m0, s34, 32768
    s_nop 0
    buffer_load_dwordx4 v6, s[4:7], s40 offen lds
    s_waitcnt vmcnt(16)
    v_mfma_f32_16x16x32_bf16 v[32:35], v[48:51], v[100:103], v[32:35]
    ds_read_b64_tr_b16 v[88:89], v152 offset:49152
    v_mfma_f32_16x16x32_bf16 v[36:39], v[52:55], v[100:103], v[36:39]
    ds_read_b64_tr_b16 v[90:91], v152 offset:50176
    v_mfma_f32_16x16x32_bf16 v[40:43], v[56:59], v[100:103], v[40:43]
    ds_read_b64_tr_b16 v[92:93], v153 offset:49152
    v_mfma_f32_16x16x32_bf16 v[44:47], v[60:63], v[100:103], v[44:47]
    ds_read_b64_tr_b16 v[94:95], v153 offset:50176
    buffer_load_dwordx4 v[100:103], v10, s[16:19], s41 offen offset:1024 sc1
    v_sub_f32 v2, 1.0, v14
    v_sub_f32 v3, 1.0, v158
    v_cvt_pk_bf16_f32 v2, v2, v3
    v_and_b32 v3, 0xffff0000, v2
    v_lshlrev_b32 v2, 16, v2
    s_add_u32 s40, s62, 12
    s_and_b32 s40, s40, 15
    s_lshl_b32 s40, s40, 17
    s_add_u32 s40, s40, s101
    s_add_u32 s40, s40, 16384
    s_add_u32 m0, s34, 33792
    s_nop 0
    buffer_load_dwordx4 v6, s[4:7], s40 offen lds
    s_waitcnt vmcnt(17) lgkmcnt(8)
    v_mfma_f32_16x16x32_bf16 v[16:19], v[64:67], v[104:107], v[16:19]
    ds_read_b64_tr_b16 v[48:49], v4 offset:53248
    v_mfma_f32_16x16x32_bf16 v[20:23], v[68:71], v[104:107], v[20:23]
    ds_read_b64_tr_b16 v[50:51], v4 offset:54272
    v_mfma_f32_16x16x32_bf16 v[24:27], v[72:75], v[104:107], v[24:27]
    ds_read_b64_tr_b16 v[52:53], v5 offset:53248
    v_mfma_f32_16x16x32_bf16 v[28:31], v[76:79], v[104:107], v[28:31]
    ds_read_b64_tr_b16 v[54:55], v5 offset:54272
    buffer_load_dwordx4 v[104:107], v10, s[16:19], s41 offen offset:2048 sc1
    s_add_u32 s40, s62, 13
    s_and_b32 s40, s40, 15
    s_lshl_b32 s40, s40, 17
    s_add_u32 s40, s40, s101
    s_add_u32 m0, s34, 49152
    s_nop 0
    buffer_load_dwordx4 v6, s[4:7], s40 offen lds
    s_waitcnt vmcnt(18)
    v_mfma_f32_16x16x32_bf16 v[32:35], v[64:67], v[108:111], v[32:35]
    ds_read_b64_tr_b16 v[56:57], v152 offset:53248
    v_mfma_f32_16x16x32_bf16 v[36:39], v[68:71], v[108:111], v[36:39]
    ds_read_b64_tr_b16 v[58:59], v152 offset:54272
    v_mfma_f32_16x16x32_bf16 v[40:43], v[72:75], v[108:111], v[40:43]
    ds_read_b64_tr_b16 v[60:61], v153 offset:53248
    v_mfma_f32_16x16x32_bf16 v[44:47], v[76:79], v[108:111], v[44:47]
    ds_read_b64_tr_b16 v[62:63], v153 offset:54272
    buffer_load_dwordx4 v[108:111], v10, s[16:19], s41 offen offset:3072 sc1
    s_cmp_eq_u32 s29, 0
    s_cselect_b64 vcc, -1, 0
    s_nop 0
    v_cndmask_b32 v166, v2, v14, vcc
    v_cndmask_b32 v168, v3, v158, vcc
    v_mov_b32 v167, v166
    v_mov_b32 v169, v168
    s_add_u32 s40, s62, 13
    s_and_b32 s40, s40, 15
    s_lshl_b32 s40, s40, 17
    s_add_u32 s40, s40, s101
    s_add_u32 s40, s40, 16384
    s_add_u32 m0, s34, 50176
    s_nop 0
    buffer_load_dwordx4 v6, s[4:7], s40 offen lds
    s_waitcnt vmcnt(19) lgkmcnt(8)
    v_mfma_f32_16x16x32_bf16 v[16:19], v[80:83], v[112:115], v[16:19]
    ds_read_b64_tr_b16 v[64:65], v154 offset:0
    v_mfma_f32_16x16x32_bf16 v[20:23], v[84:87], v[112:115], v[20:23]
    ds_read_b64_tr_b16 v[66:67], v154 offset:1024
    v_mfma_f32_16x16x32_bf16 v[24:27], v[88:91], v[112:115], v[24:27]
    ds_read_b64_tr_b16 v[68:69], v155 offset:0
    v_mfma_f32_16x16x32_bf16 v[28:31], v[92:95], v[112:115], v[28:31]
    ds_read_b64_tr_b16 v[70:71], v155 offset:1024
    s_add_u32 s41, s62, 10
    s_and_b32 s41, s41, 15
    s_lshl_b32 s41, s41, 12
    s_add_u32 s41, s41, s100
    buffer_load_dwordx4 v[112:115], v10, s[16:19], s41 offen offset:0 sc1
    s_add_u32 s40, s62, 14
    s_and_b32 s40, s40, 15
    s_lshl_b32 s40, s40, 17
    s_add_u32 s40, s40, s101
    s_add_u32 m0, s34, 65536
    s_nop 0
    buffer_load_dwordx4 v6, s[4:7], s40 offen lds
    s_waitcnt vmcnt(20)
    v_mfma_f32_16x16x32_bf16 v[32:35], v[80:83], v[116:119], v[32:35]
    ds_read_b64_tr_b16 v[72:73], v156 offset:0
    v_mfma_f32_16x16x32_bf16 v[36:39], v[84:87], v[116:119], v[36:39]
    ds_read_b64_tr_b16 v[74:75], v156 offset:1024
    v_mfma_f32_16x16x32_bf16 v[40:43], v[88:91], v[116:119], v[40:43]
    ds_read_b64_tr_b16 v[76:77], v157 offset:0
    v_mfma_f32_16x16x32_bf16 v[44:47], v[92:95], v[116:119], v[44:47]
    ds_read_b64_tr_b16 v[78:79], v157 offset:1024
    buffer_load_dwordx4 v[116:119], v10, s[16:19], s41 offen offset:1024 sc1
    s_add_u32 s40, s62, 14
    s_and_b32 s40, s40, 15
    s_lshl_b32 s40, s40, 17
    s_add_u32 s40, s40, s101
    s_add_u32 s40, s40, 16384
    s_add_u32 m0, s34, 66560
    s_nop 0
    buffer_load_dwordx4 v6, s[4:7], s40 offen lds
    s_waitcnt vmcnt(21) lgkmcnt(8)
    v_mfma_f32_16x16x32_bf16 v[16:19], v[48:51], v[120:123], v[16:19]
    ds_read_b64_tr_b16 v[80:81], v154 offset:4096
    v_mfma_f32_16x16x32_bf16 v[20:23], v[52:55], v[120:123], v[20:23]
    ds_read_b64_tr_b16 v[82:83], v154 offset:5120
    v_mfma_f32_16x16x32_bf16 v[24:27], v[56:59], v[120:123], v[24:27]
    ds_read_b64_tr_b16 v[84:85], v155 offset:4096
    v_mfma_f32_16x16x32_bf16 v[28:31], v[60:63], v[120:123], v[28:31]
    ds_read_b64_tr_b16 v[86:87], v155 offset:5120
    buffer_load_dwordx4 v[120:123], v10, s[16:19], s41 offen offset:2048 sc1
    s_add_u32 s40, s62, 15
    s_and_b32 s40, s40, 15
    s_lshl_b32 s40, s40, 17
    s_add_u32 s40, s40, s101
    s_add_u32 m0, s34, 81920
    s_nop 0
    buffer_load_dwordx4 v6, s[4:7], s40 offen lds
    s_waitcnt vmcnt(22)
    v_mfma_f32_16x16x32_bf16 v[32:35], v[48:51], v[124:127], v[32:35]
    ds_read_b64_tr_b16 v[88:89], v156 offset:4096
    v_mfma_f32_16x16x32_bf16 v[36:39], v[52:55], v[124:127], v[36:39]
    ds_read_b64_tr_b16 v[90:91], v156 offset:5120
    v_mfma_f32_16x16x32_bf16 v[40:43], v[56:59], v[124:127], v[40:43]
    ds_read_b64_tr_b16 v[92:93], v157 offset:4096
    v_mfma_f32_16x16x32_bf16 v[44:47], v[60:63], v[124:127], v[44:47]
    ds_read_b64_tr_b16 v[94:95], v157 offset:5120
    buffer_load_dwordx4 v[124:127], v10, s[16:19], s41 offen offset:3072 sc1
    s_add_u32 s40, s62, 15
    s_and_b32 s40, s40, 15
    s_lshl_b32 s40, s40, 17
    s_add_u32 s40, s40, s101
    s_add_u32 s40, s40, 16384
    s_add_u32 m0, s34, 82944
    s_nop 0
    buffer_load_dwordx4 v6, s[4:7], s40 offen lds
    s_waitcnt vmcnt(23) lgkmcnt(8)
    v_mfma_f32_16x16x32_bf16 v[16:19], v[64:67], v[128:131], v[16:19]
    ds_read_b64_tr_b16 v[48:49], v154 offset:16384
    v_mfma_f32_16x16x32_bf16 v[20:23], v[68:71], v[128:131], v[20:23]
    ds_read_b64_tr_b16 v[50:51], v154 offset:17408
    v_mfma_f32_16x16x32_bf16 v[24:27], v[72:75], v[128:131], v[24:27]
    ds_read_b64_tr_b16 v[52:53], v155 offset:16384
    v_mfma_f32_16x16x32_bf16 v[28:31], v[76:79], v[128:131], v[28:31]
    ds_read_b64_tr_b16 v[54:55], v155 offset:17408
    s_add_u32 s41, s62, 11
    s_and_b32 s41, s41, 15
    s_lshl_b32 s41, s41, 12
    s_add_u32 s41, s41, s100
    buffer_load_dwordx4 v[128:131], v10, s[16:19], s41 offen offset:0 sc1
    s_waitcnt vmcnt(22)
    v_mfma_f32_16x16x32_bf16 v[32:35], v[64:67], v[132:135], v[32:35]
    ds_read_b64_tr_b16 v[56:57], v156 offset:16384
    v_mfma_f32_16x16x32_bf16 v[36:39], v[68:71], v[132:135], v[36:39]
    ds_read_b64_tr_b16 v[58:59], v156 offset:17408
    v_mfma_f32_16x16x32_bf16 v[40:43], v[72:75], v[132:135], v[40:43]
    ds_read_b64_tr_b16 v[60:61], v157 offset:16384
    v_mfma_f32_16x16x32_bf16 v[44:47], v[76:79], v[132:135], v[44:47]
    ds_read_b64_tr_b16 v[62:63], v157 offset:17408
    buffer_load_dwordx4 v[132:135], v10, s[16:19], s41 offen offset:1024 sc1
    s_waitcnt vmcnt(21) lgkmcnt(8)
    v_mfma_f32_16x16x32_bf16 v[16:19], v[80:83], v[136:139], v[16:19]
    ds_read_b64_tr_b16 v[64:65], v154 offset:20480
    v_mfma_f32_16x16x32_bf16 v[20:23], v[84:87], v[136:139], v[20:23]
    ds_read_b64_tr_b16 v[66:67], v154 offset:21504
    v_mfma_f32_16x16x32_bf16 v[24:27], v[88:91], v[136:139], v[24:27]
    ds_read_b64_tr_b16 v[68:69], v155 offset:20480
    v_mfma_f32_16x16x32_bf16 v[28:31], v[92:95], v[136:139], v[28:31]
    ds_read_b64_tr_b16 v[70:71], v155 offset:21504
    buffer_load_dwordx4 v[136:139], v10, s[16:19], s41 offen offset:2048 sc1
    s_waitcnt vmcnt(20)
    v_mfma_f32_16x16x32_bf16 v[32:35], v[80:83], v[140:143], v[32:35]
    ds_read_b64_tr_b16 v[72:73], v156 offset:20480
    v_mfma_f32_16x16x32_bf16 v[36:39], v[84:87], v[140:143], v[36:39]
    ds_read_b64_tr_b16 v[74:75], v156 offset:21504
    v_mfma_f32_16x16x32_bf16 v[40:43], v[88:91], v[140:143], v[40:43]
    ds_read_b64_tr_b16 v[76:77], v157 offset:20480
    v_mfma_f32_16x16x32_bf16 v[44:47], v[92:95], v[140:143], v[44:47]
    ds_read_b64_tr_b16 v[78:79], v157 offset:21504
    buffer_load_dwordx4 v[140:143], v10, s[16:19], s41 offen offset:3072 sc1
    s_waitcnt vmcnt(4) lgkmcnt(0)
    s_barrier
    v_mfma_f32_16x16x32_bf16 v[16:19], v[48:51], v[96:99], v[16:19]
    ds_read_b64_tr_b16 v[80:81], v7 offset:0
    v_mfma_f32_16x16x32_bf16 v[20:23], v[52:55], v[96:99], v[20:23]
    ds_read_b64_tr_b16 v[82:83], v7 offset:1024
    v_mfma_f32_16x16x32_bf16 v[24:27], v[56:59], v[96:99], v[24:27]
    ds_read_b64_tr_b16 v[84:85], v8 offset:0
    v_mfma_f32_16x16x32_bf16 v[28:31], v[60:63], v[96:99], v[28:31]
    ds_read_b64_tr_b16 v[86:87], v8 offset:1024
    s_add_u32 s41, s62, 12
    s_and_b32 s41, s41, 15
    s_lshl_b32 s41, s41, 12
    s_add_u32 s41, s41, s100
    buffer_load_dwordx4 v[96:99], v10, s[16:19], s41 offen offset:0 sc1
    s_waitcnt vmcnt(5)
    v_mfma_f32_16x16x32_bf16 v[32:35], v[48:51], v[100:103], v[32:35]
    ds_read_b64_tr_b16 v[88:89], v9 offset:0
    v_mfma_f32_16x16x32_bf16 v[36:39], v[52:55], v[100:103], v[36:39]
    ds_read_b64_tr_b16 v[90:91], v9 offset:1024
    v_mfma_f32_16x16x32_bf16 v[40:43], v[56:59], v[100:103], v[40:43]
    ds_read_b64_tr_b16 v[92:93], v11 offset:0
    v_mfma_f32_16x16x32_bf16 v[44:47], v[60:63], v[100:103], v[44:47]
    ds_read_b64_tr_b16 v[94:95], v11 offset:1024
    buffer_load_dwordx4 v[100:103], v10, s[16:19], s41 offen offset:1024 sc1
    s_waitcnt vmcnt(6) lgkmcnt(8)
    v_mfma_f32_16x16x32_bf16 v[16:19], v[64:67], v[104:107], v[16:19]
    ds_read_b64_tr_b16 v[48:49], v7 offset:4096
    v_mfma_f32_16x16x32_bf16 v[20:23], v[68:71], v[104:107], v[20:23]
    ds_read_b64_tr_b16 v[50:51], v7 offset:5120
    v_mfma_f32_16x16x32_bf16 v[24:27], v[72:75], v[104:107], v[24:27]
    ds_read_b64_tr_b16 v[52:53], v8 offset:4096
    v_mfma_f32_16x16x32_bf16 v[28:31], v[76:79], v[104:107], v[28:31]
    ds_read_b64_tr_b16 v[54:55], v8 offset:5120
    buffer_load_dwordx4 v[104:107], v10, s[16:19], s41 offen offset:2048 sc1
    s_waitcnt vmcnt(7)
    v_mfma_f32_16x16x32_bf16 v[32:35], v[64:67], v[108:111], v[32:35]
    ds_read_b64_tr_b16 v[56:57], v9 offset:4096
    v_mfma_f32_16x16x32_bf16 v[36:39], v[68:71], v[108:111], v[36:39]
    ds_read_b64_tr_b16 v[58:59], v9 offset:5120
    v_mfma_f32_16x16x32_bf16 v[40:43], v[72:75], v[108:111], v[40:43]
    ds_read_b64_tr_b16 v[60:61], v11 offset:4096
    v_mfma_f32_16x16x32_bf16 v[44:47], v[76:79], v[108:111], v[44:47]
    ds_read_b64_tr_b16 v[62:63], v11 offset:5120
    buffer_load_dwordx4 v[108:111], v10, s[16:19], s41 offen offset:3072 sc1
    s_waitcnt vmcnt(8) lgkmcnt(8)
    v_mfma_f32_16x16x32_bf16 v[16:19], v[80:83], v[112:115], v[16:19]
    ds_read_b64_tr_b16 v[64:65], v7 offset:16384
    v_mfma_f32_16x16x32_bf16 v[20:23], v[84:87], v[112:115], v[20:23]
    ds_read_b64_tr_b16 v[66:67], v7 offset:17408
    v_mfma_f32_16x16x32_bf16 v[24:27], v[88:91], v[112:115], v[24:27]
    ds_read_b64_tr_b16 v[68:69], v8 offset:16384
    v_mfma_f32_16x16x32_bf16 v[28:31], v[92:95], v[112:115], v[28:31]
    ds_read_b64_tr_b16 v[70:71], v8 offset:17408
    s_add_u32 s41, s62, 13
    s_and_b32 s41, s41, 15
    s_lshl_b32 s41, s41, 12
    s_add_u32 s41, s41, s100
    buffer_load_dwordx4 v[112:115], v10, s[16:19], s41 offen offset:0 sc1
    s_waitcnt vmcnt(9)
    v_mfma_f32_16x16x32_bf16 v[32:35], v[80:83], v[116:119], v[32:35]
    ds_read_b64_tr_b16 v[72:73], v9 offset:16384
    v_mfma_f32_16x16x32_bf16 v[36:39], v[84:87], v[116:119], v[36:39]
    ds_read_b64_tr_b16 v[74:75], v9 offset:17408
    v_mfma_f32_16x16x32_bf16 v[40:43], v[88:91], v[116:119], v[40:43]
    ds_read_b64_tr_b16 v[76:77], v11 offset:16384
    v_mfma_f32_16x16x32_bf16 v[44:47], v[92:95], v[116:119], v[44:47]
    ds_read_b64_tr_b16 v[78:79], v11 offset:17408
    buffer_load_dwordx4 v[116:119], v10, s[16:19], s41 offen offset:1024 sc1
    s_waitcnt vmcnt(10) lgkmcnt(8)
    v_mfma_f32_16x16x32_bf16 v[16:19], v[48:51], v[120:123], v[16:19]
    ds_read_b64_tr_b16 v[80:81], v7 offset:20480
    v_mfma_f32_16x16x32_bf16 v[20:23], v[52:55], v[120:123], v[20:23]
    ds_read_b64_tr_b16 v[82:83], v7 offset:21504
    v_mfma_f32_16x16x32_bf16 v[24:27], v[56:59], v[120:123], v[24:27]
    ds_read_b64_tr_b16 v[84:85], v8 offset:20480
    v_mfma_f32_16x16x32_bf16 v[28:31], v[60:63], v[120:123], v[28:31]
    ds_read_b64_tr_b16 v[86:87], v8 offset:21504
    buffer_load_dwordx4 v[120:123], v10, s[16:19], s41 offen offset:2048 sc1
    s_waitcnt vmcnt(11)
    v_mfma_f32_16x16x32_bf16 v[32:35], v[48:51], v[124:127], v[32:35]
    ds_read_b64_tr_b16 v[88:89], v9 offset:20480
    v_mfma_f32_16x16x32_bf16 v[36:39], v[52:55], v[124:127], v[36:39]
    ds_read_b64_tr_b16 v[90:91], v9 offset:21504
    v_mfma_f32_16x16x32_bf16 v[40:43], v[56:59], v[124:127], v[40:43]
    ds_read_b64_tr_b16 v[92:93], v11 offset:20480
    v_mfma_f32_16x16x32_bf16 v[44:47], v[60:63], v[124:127], v[44:47]
    ds_read_b64_tr_b16 v[94:95], v11 offset:21504
    buffer_load_dwordx4 v[124:127], v10, s[16:19], s41 offen offset:3072 sc1
    s_waitcnt vmcnt(11) lgkmcnt(8)
    v_mfma_f32_16x16x32_bf16 v[16:19], v[64:67], v[128:131], v[16:19]
    ds_read_b64_tr_b16 v[48:49], v7 offset:32768
    v_mfma_f32_16x16x32_bf16 v[20:23], v[68:71], v[128:131], v[20:23]
    ds_read_b64_tr_b16 v[50:51], v7 offset:33792
    v_mfma_f32_16x16x32_bf16 v[24:27], v[72:75], v[128:131], v[24:27]
    ds_read_b64_tr_b16 v[52:53], v8 offset:32768
    v_mfma_f32_16x16x32_bf16 v[28:31], v[76:79], v[128:131], v[28:31]
    ds_read_b64_tr_b16 v[54:55], v8 offset:33792
    s_add_u32 s41, s62, 14
    s_and_b32 s41, s41, 15
    s_lshl_b32 s41, s41, 12
    s_add_u32 s41, s41, s100
    buffer_load_dwordx4 v[128:131], v10, s[16:19], s41 offen offset:0 sc1
    s_waitcnt vmcnt(11)
    v_mfma_f32_16x16x32_bf16 v[32:35], v[64:67], v[132:135], v[32:35]
    ds_read_b64_tr_b16 v[56:57], v9 offset:32768
    v_mfma_f32_16x16x32_bf16 v[36:39], v[68:71], v[132:135], v[36:39]
    ds_read_b64_tr_b16 v[58:59], v9 offset:33792
    v_mfma_f32_16x16x32_bf16 v[40:43], v[72:75], v[132:135], v[40:43]
    ds_read_b64_tr_b16 v[60:61], v11 offset:32768
    v_mfma_f32_16x16x32_bf16 v[44:47], v[76:79], v[132:135], v[44:47]
    ds_read_b64_tr_b16 v[62:63], v11 offset:33792
    buffer_load_dwordx4 v[132:135], v10, s[16:19], s41 offen offset:1024 sc1
    s_waitcnt vmcnt(11) lgkmcnt(8)
    v_mfma_f32_16x16x32_bf16 v[16:19], v[80:83], v[136:139], v[16:19]
    ds_read_b64_tr_b16 v[64:65], v7 offset:36864
    v_mfma_f32_16x16x32_bf16 v[20:23], v[84:87], v[136:139], v[20:23]
    ds_read_b64_tr_b16 v[66:67], v7 offset:37888
    v_mfma_f32_16x16x32_bf16 v[24:27], v[88:91], v[136:139], v[24:27]
    ds_read_b64_tr_b16 v[68:69], v8 offset:36864
    v_mfma_f32_16x16x32_bf16 v[28:31], v[92:95], v[136:139], v[28:31]
    ds_read_b64_tr_b16 v[70:71], v8 offset:37888
    buffer_load_dwordx4 v[136:139], v10, s[16:19], s41 offen offset:2048 sc1
    s_waitcnt vmcnt(11)
    v_mfma_f32_16x16x32_bf16 v[32:35], v[80:83], v[140:143], v[32:35]
    ds_read_b64_tr_b16 v[72:73], v9 offset:36864
    v_mfma_f32_16x16x32_bf16 v[36:39], v[84:87], v[140:143], v[36:39]
    ds_read_b64_tr_b16 v[74:75], v9 offset:37888
    v_mfma_f32_16x16x32_bf16 v[40:43], v[88:91], v[140:143], v[40:43]
    ds_read_b64_tr_b16 v[76:77], v11 offset:36864
    v_mfma_f32_16x16x32_bf16 v[44:47], v[92:95], v[140:143], v[44:47]
    ds_read_b64_tr_b16 v[78:79], v11 offset:37888
    buffer_load_dwordx4 v[140:143], v10, s[16:19], s41 offen offset:3072 sc1
    s_waitcnt vmcnt(11) lgkmcnt(8)
    v_mfma_f32_16x16x32_bf16 v[16:19], v[48:51], v[96:99], v[16:19]
    ds_read_b64_tr_b16 v[80:81], v7 offset:49152
    v_mfma_f32_16x16x32_bf16 v[20:23], v[52:55], v[96:99], v[20:23]
    ds_read_b64_tr_b16 v[82:83], v7 offset:50176
    v_mfma_f32_16x16x32_bf16 v[24:27], v[56:59], v[96:99], v[24:27]
    ds_read_b64_tr_b16 v[84:85], v8 offset:49152
    v_mfma_f32_16x16x32_bf16 v[28:31], v[60:63], v[96:99], v[28:31]
    ds_read_b64_tr_b16 v[86:87], v8 offset:50176
    s_add_u32 s41, s62, 15
    s_and_b32 s41, s41, 15
    s_lshl_b32 s41, s41, 12
    s_add_u32 s41, s41, s100
    buffer_load_dwordx4 v[96:99], v10, s[16:19], s41 offen offset:0 sc1
    s_waitcnt vmcnt(11)
    v_mfma_f32_16x16x32_bf16 v[32:35], v[48:51], v[100:103], v[32:35]
    ds_read_b64_tr_b16 v[88:89], v9 offset:49152
    v_mfma_f32_16x16x32_bf16 v[36:39], v[52:55], v[100:103], v[36:39]
    ds_read_b64_tr_b16 v[90:91], v9 offset:50176
    v_mfma_f32_16x16x32_bf16 v[40:43], v[56:59], v[100:103], v[40:43]
    ds_read_b64_tr_b16 v[92:93], v11 offset:49152
    v_mfma_f32_16x16x32_bf16 v[44:47], v[60:63], v[100:103], v[44:47]
    ds_read_b64_tr_b16 v[94:95], v11 offset:50176
    buffer_load_dwordx4 v[100:103], v10, s[16:19], s41 offen offset:1024 sc1
    s_waitcnt vmcnt(11) lgkmcnt(8)
    v_mfma_f32_16x16x32_bf16 v[16:19], v[64:67], v[104:107], v[16:19]
    ds_read_b64_tr_b16 v[48:49], v7 offset:53248
    v_mfma_f32_16x16x32_bf16 v[20:23], v[68:71], v[104:107], v[20:23]
    ds_read_b64_tr_b16 v[50:51], v7 offset:54272
    v_mfma_f32_16x16x32_bf16 v[24:27], v[72:75], v[104:107], v[24:27]
    ds_read_b64_tr_b16 v[52:53], v8 offset:53248
    v_mfma_f32_16x16x32_bf16 v[28:31], v[76:79], v[104:107], v[28:31]
    ds_read_b64_tr_b16 v[54:55], v8 offset:54272
    buffer_load_dwordx4 v[104:107], v10, s[16:19], s41 offen offset:2048 sc1
    s_waitcnt vmcnt(11)
    v_mfma_f32_16x16x32_bf16 v[32:35], v[64:67], v[108:111], v[32:35]
    ds_read_b64_tr_b16 v[56:57], v9 offset:53248
    v_mfma_f32_16x16x32_bf16 v[36:39], v[68:71], v[108:111], v[36:39]
    ds_read_b64_tr_b16 v[58:59], v9 offset:54272
    v_mfma_f32_16x16x32_bf16 v[40:43], v[72:75], v[108:111], v[40:43]
    ds_read_b64_tr_b16 v[60:61], v11 offset:53248
    v_mfma_f32_16x16x32_bf16 v[44:47], v[76:79], v[108:111], v[44:47]
    ds_read_b64_tr_b16 v[62:63], v11 offset:54272
    buffer_load_dwordx4 v[108:111], v10, s[16:19], s41 offen offset:3072 sc1
    s_waitcnt vmcnt(11) lgkmcnt(8)
    v_mfma_f32_16x16x32_bf16 v[16:19], v[80:83], v[112:115], v[16:19]
    ds_read_b64_tr_b16 v[64:65], v4 offset:0
    v_mfma_f32_16x16x32_bf16 v[20:23], v[84:87], v[112:115], v[20:23]
    ds_read_b64_tr_b16 v[66:67], v4 offset:1024
    v_mfma_f32_16x16x32_bf16 v[24:27], v[88:91], v[112:115], v[24:27]
    ds_read_b64_tr_b16 v[68:69], v5 offset:0
    v_mfma_f32_16x16x32_bf16 v[28:31], v[92:95], v[112:115], v[28:31]
    ds_read_b64_tr_b16 v[70:71], v5 offset:1024
    s_waitcnt vmcnt(10)
    v_mfma_f32_16x16x32_bf16 v[32:35], v[80:83], v[116:119], v[32:35]
    ds_read_b64_tr_b16 v[72:73], v152 offset:0
    v_mfma_f32_16x16x32_bf16 v[36:39], v[84:87], v[116:119], v[36:39]
    ds_read_b64_tr_b16 v[74:75], v152 offset:1024
    v_mfma_f32_16x16x32_bf16 v[40:43], v[88:91], v[116:119], v[40:43]
    ds_read_b64_tr_b16 v[76:77], v153 offset:0
    v_mfma_f32_16x16x32_bf16 v[44:47], v[92:95], v[116:119], v[44:47]
    ds_read_b64_tr_b16 v[78:79], v153 offset:1024
    s_waitcnt vmcnt(9) lgkmcnt(8)
    v_mfma_f32_16x16x32_bf16 v[16:19], v[48:51], v[120:123], v[16:19]
    ds_read_b64_tr_b16 v[80:81], v4 offset:4096
    v_mfma_f32_16x16x32_bf16 v[20:23], v[52:55], v[120:123], v[20:23]
    ds_read_b64_tr_b16 v[82:83], v4 offset:5120
    v_mfma_f32_16x16x32_bf16 v[24:27], v[56:59], v[120:123], v[24:27]
    ds_read_b64_tr_b16 v[84:85], v5 offset:4096
    v_mfma_f32_16x16x32_bf16 v[28:31], v[60:63], v[120:123], v[28:31]
    ds_read_b64_tr_b16 v[86:87], v5 offset:5120
    s_waitcnt vmcnt(8)
    v_mfma_f32_16x16x32_bf16 v[32:35], v[48:51], v[124:127], v[32:35]
    ds_read_b64_tr_b16 v[88:89], v152 offset:4096
    v_mfma_f32_16x16x32_bf16 v[36:39], v[52:55], v[124:127], v[36:39]
    ds_read_b64_tr_b16 v[90:91], v152 offset:5120
    v_mfma_f32_16x16x32_bf16 v[40:43], v[56:59], v[124:127], v[40:43]
    ds_read_b64_tr_b16 v[92:93], v153 offset:4096
    v_mfma_f32_16x16x32_bf16 v[44:47], v[60:63], v[124:127], v[44:47]
    ds_read_b64_tr_b16 v[94:95], v153 offset:5120
    s_waitcnt vmcnt(7) lgkmcnt(8)
    v_mfma_f32_16x16x32_bf16 v[16:19], v[64:67], v[128:131], v[16:19]
    ds_read_b64_tr_b16 v[48:49], v4 offset:16384
    v_mfma_f32_16x16x32_bf16 v[20:23], v[68:71], v[128:131], v[20:23]
    ds_read_b64_tr_b16 v[50:51], v4 offset:17408
    v_mfma_f32_16x16x32_bf16 v[24:27], v[72:75], v[128:131], v[24:27]
    ds_read_b64_tr_b16 v[52:53], v5 offset:16384
    v_mfma_f32_16x16x32_bf16 v[28:31], v[76:79], v[128:131], v[28:31]
    ds_read_b64_tr_b16 v[54:55], v5 offset:17408
    s_waitcnt vmcnt(6)
    v_mfma_f32_16x16x32_bf16 v[32:35], v[64:67], v[132:135], v[32:35]
    ds_read_b64_tr_b16 v[56:57], v152 offset:16384
    v_mfma_f32_16x16x32_bf16 v[36:39], v[68:71], v[132:135], v[36:39]
    ds_read_b64_tr_b16 v[58:59], v152 offset:17408
    v_mfma_f32_16x16x32_bf16 v[40:43], v[72:75], v[132:135], v[40:43]
    ds_read_b64_tr_b16 v[60:61], v153 offset:16384
    v_mfma_f32_16x16x32_bf16 v[44:47], v[76:79], v[132:135], v[44:47]
    ds_read_b64_tr_b16 v[62:63], v153 offset:17408
    s_waitcnt vmcnt(5) lgkmcnt(8)
    v_mfma_f32_16x16x32_bf16 v[16:19], v[80:83], v[136:139], v[16:19]
    ds_read_b64_tr_b16 v[64:65], v4 offset:20480
    v_mfma_f32_16x16x32_bf16 v[20:23], v[84:87], v[136:139], v[20:23]
    ds_read_b64_tr_b16 v[66:67], v4 offset:21504
    v_mfma_f32_16x16x32_bf16 v[24:27], v[88:91], v[136:139], v[24:27]
    ds_read_b64_tr_b16 v[68:69], v5 offset:20480
    v_mfma_f32_16x16x32_bf16 v[28:31], v[92:95], v[136:139], v[28:31]
    ds_read_b64_tr_b16 v[70:71], v5 offset:21504
    s_waitcnt vmcnt(4)
    v_mfma_f32_16x16x32_bf16 v[32:35], v[80:83], v[140:143], v[32:35]
    ds_read_b64_tr_b16 v[72:73], v152 offset:20480
    v_mfma_f32_16x16x32_bf16 v[36:39], v[84:87], v[140:143], v[36:39]
    ds_read_b64_tr_b16 v[74:75], v152 offset:21504
    v_mfma_f32_16x16x32_bf16 v[40:43], v[88:91], v[140:143], v[40:43]
    ds_read_b64_tr_b16 v[76:77], v153 offset:20480
    v_mfma_f32_16x16x32_bf16 v[44:47], v[92:95], v[140:143], v[44:47]
    ds_read_b64_tr_b16 v[78:79], v153 offset:21504
    s_waitcnt vmcnt(3) lgkmcnt(8)
    v_mfma_f32_16x16x32_bf16 v[16:19], v[48:51], v[96:99], v[16:19]
    v_mfma_f32_16x16x32_bf16 v[20:23], v[52:55], v[96:99], v[20:23]
    v_mfma_f32_16x16x32_bf16 v[24:27], v[56:59], v[96:99], v[24:27]
    v_mfma_f32_16x16x32_bf16 v[28:31], v[60:63], v[96:99], v[28:31]
    s_waitcnt vmcnt(2)
    v_mfma_f32_16x16x32_bf16 v[32:35], v[48:51], v[100:103], v[32:35]
    v_mfma_f32_16x16x32_bf16 v[36:39], v[52:55], v[100:103], v[36:39]
    v_mfma_f32_16x16x32_bf16 v[40:43], v[56:59], v[100:103], v[40:43]
    v_mfma_f32_16x16x32_bf16 v[44:47], v[60:63], v[100:103], v[44:47]
    s_waitcnt vmcnt(1) lgkmcnt(0)
    v_mfma_f32_16x16x32_bf16 v[16:19], v[64:67], v[104:107], v[16:19]
    v_mfma_f32_16x16x32_bf16 v[20:23], v[68:71], v[104:107], v[20:23]
    v_mfma_f32_16x16x32_bf16 v[24:27], v[72:75], v[104:107], v[24:27]
    v_mfma_f32_16x16x32_bf16 v[28:31], v[76:79], v[104:107], v[28:31]
    s_waitcnt vmcnt(0)
    v_mfma_f32_16x16x32_bf16 v[32:35], v[64:67], v[108:111], v[32:35]
    v_mfma_f32_16x16x32_bf16 v[36:39], v[68:71], v[108:111], v[36:39]
    v_mfma_f32_16x16x32_bf16 v[40:43], v[72:75], v[108:111], v[40:43]
    v_mfma_f32_16x16x32_bf16 v[44:47], v[76:79], v[108:111], v[44:47]
    s_nop 7
    v_pk_mul_f32 v[16:17], v[16:17], v[166:167]
    v_pk_mul_f32 v[18:19], v[18:19], v[166:167]
    v_cvt_pk_bf16_f32 v16, v16, v17
    v_cvt_pk_bf16_f32 v17, v18, v19
    ds_write_b64 v160, v[16:17] offset:0
    v_pk_mul_f32 v[20:21], v[20:21], v[166:167]
    v_pk_mul_f32 v[22:23], v[22:23], v[166:167]
    v_cvt_pk_bf16_f32 v20, v20, v21
    v_cvt_pk_bf16_f32 v21, v22, v23
    ds_write_b64 v161, v[20:21] offset:0
    v_pk_mul_f32 v[24:25], v[24:25], v[166:167]
    v_pk_mul_f32 v[26:27], v[26:27], v[166:167]
    v_cvt_pk_bf16_f32 v24, v24, v25
    v_cvt_pk_bf16_f32 v25, v26, v27
    ds_write_b64 v162, v[24:25] offset:0
    v_pk_mul_f32 v[28:29], v[28:29], v[166:167]
    v_pk_mul_f32 v[30:31], v[30:31], v[166:167]
    v_cvt_pk_bf16_f32 v28, v28, v29
    v_cvt_pk_bf16_f32 v29, v30, v31
    ds_write_b64 v163, v[28:29] offset:0
    v_pk_mul_f32 v[32:33], v[32:33], v[168:169]
    v_pk_mul_f32 v[34:35], v[34:35], v[168:169]
    v_cvt_pk_bf16_f32 v32, v32, v33
    v_cvt_pk_bf16_f32 v33, v34, v35
    ds_write_b64 v160, v[32:33] offset:2048
    v_pk_mul_f32 v[36:37], v[36:37], v[168:169]
    v_pk_mul_f32 v[38:39], v[38:39], v[168:169]
    v_cvt_pk_bf16_f32 v36, v36, v37
    v_cvt_pk_bf16_f32 v37, v38, v39
    ds_write_b64 v161, v[36:37] offset:2048
    v_pk_mul_f32 v[40:41], v[40:41], v[168:169]
    v_pk_mul_f32 v[42:43], v[42:43], v[168:169]
    v_cvt_pk_bf16_f32 v40, v40, v41
    v_cvt_pk_bf16_f32 v41, v42, v43
    ds_write_b64 v162, v[40:41] offset:2048
    v_pk_mul_f32 v[44:45], v[44:45], v[168:169]
    v_pk_mul_f32 v[46:47], v[46:47], v[168:169]
    v_cvt_pk_bf16_f32 v44, v44, v45
    v_cvt_pk_bf16_f32 v45, v46, v47
    ds_write_b64 v163, v[44:45] offset:2048
    s_lshl_b32 s40, s61, 7
    s_add_u32 s41, s40, 16384
    s_waitcnt lgkmcnt(0)
    s_barrier
    ds_read_b128 v[16:19], v164
    ds_read_b128 v[20:23], v164 offset:16384
    ds_read_b128 v[24:27], v164 offset:1024
    ds_read_b128 v[28:31], v164 offset:17408
    s_waitcnt lgkmcnt(2)
    v_lshlrev_b32 v48, 16, v16
    v_and_b32 v49, 0xffff0000, v16
    v_lshlrev_b32 v50, 16, v20
    v_and_b32 v51, 0xffff0000, v20
    v_pk_add_f32 v[48:49], v[48:49], v[50:51]
    v_cvt_pk_bf16_f32 v32, v48, v49
    v_lshlrev_b32 v48, 16, v17
    v_and_b32 v49, 0xffff0000, v17
    v_lshlrev_b32 v50, 16, v21
    v_and_b32 v51, 0xffff0000, v21
    v_pk_add_f32 v[48:49], v[48:49], v[50:51]
    v_cvt_pk_bf16_f32 v33, v48, v49
    v_lshlrev_b32 v48, 16, v18
    v_and_b32 v49, 0xffff0000, v18
    v_lshlrev_b32 v50, 16, v22
    v_and_b32 v51, 0xffff0000, v22
    v_pk_add_f32 v[48:49], v[48:49], v[50:51]
    v_cvt_pk_bf16_f32 v34, v48, v49
    v_lshlrev_b32 v48, 16, v19
    v_and_b32 v49, 0xffff0000, v19
    v_lshlrev_b32 v50, 16, v23
    v_and_b32 v51, 0xffff0000, v23
    v_pk_add_f32 v[48:49], v[48:49], v[50:51]
    v_cvt_pk_bf16_f32 v35, v48, v49
    buffer_store_dwordx4 v[32:35], v13, s[56:59], s40 offen sc1
    s_waitcnt lgkmcnt(0)
    v_lshlrev_b32 v48, 16, v24
    v_and_b32 v49, 0xffff0000, v24
    v_lshlrev_b32 v50, 16, v28
    v_and_b32 v51, 0xffff0000, v28
    v_pk_add_f32 v[48:49], v[48:49], v[50:51]
    v_cvt_pk_bf16_f32 v36, v48, v49
    v_lshlrev_b32 v48, 16, v25
    v_and_b32 v49, 0xffff0000, v25
    v_lshlrev_b32 v50, 16, v29
    v_and_b32 v51, 0xffff0000, v29
    v_pk_add_f32 v[48:49], v[48:49], v[50:51]
    v_cvt_pk_bf16_f32 v37, v48, v49
    v_lshlrev_b32 v48, 16, v26
    v_and_b32 v49, 0xffff0000, v26
    v_lshlrev_b32 v50, 16, v30
    v_and_b32 v51, 0xffff0000, v30
    v_pk_add_f32 v[48:49], v[48:49], v[50:51]
    v_cvt_pk_bf16_f32 v38, v48, v49
    v_lshlrev_b32 v48, 16, v27
    v_and_b32 v49, 0xffff0000, v27
    v_lshlrev_b32 v50, 16, v31
    v_and_b32 v51, 0xffff0000, v31
    v_pk_add_f32 v[48:49], v[48:49], v[50:51]
    v_cvt_pk_bf16_f32 v39, v48, v49
    buffer_store_dwordx4 v[36:39], v13, s[56:59], s41 offen sc1
L_end12:
    s_endpgm

.section .rodata,"a"
.p2align 6
.amdhsa_kernel gated_mix__mha_block__softmax_full_mha__prompt_kernel
  .amdhsa_next_free_vgpr 256
  .amdhsa_next_free_sgpr 102
  .amdhsa_accum_offset 256
  .amdhsa_group_segment_fixed_size 0
  .amdhsa_kernarg_size 80
  .amdhsa_user_sgpr_count 2
  .amdhsa_user_sgpr_kernarg_segment_ptr 1
  .amdhsa_system_sgpr_workgroup_id_x 1
  .amdhsa_float_denorm_mode_32 3
.end_amdhsa_kernel
```
